```python
import torch

def _softmax(x, axis=-1):
    return torch.softmax(x, dim=axis)
def _gelu(x):
    return torch.nn.functional.gelu(x, approximate="tanh")
def _silu(x):
    return torch.nn.functional.silu(x)
def _sigmoid(x):
    return torch.sigmoid(x)
def _layernorm(x, axis=-1, eps=1e-5):
    m = x.mean(dim=axis, keepdim=True)
    v = x.var(dim=axis, keepdim=True, unbiased=False)
    return (x - m) / torch.sqrt(v + eps)
def _scatter_add(tgt, idx, src, axis=0):
    return tgt.clone().index_add_(axis, idx, src)
def _segment_sum(src, seg, n):
    out = torch.zeros((n,) + src.shape[1:], dtype=src.dtype)
    return out.index_add_(0, seg, src)
def _pad(x, pw):
    flat = tuple(v for pair in reversed(pw) for v in pair)
    return torch.nn.functional.pad(x, flat)

kernel_name = 'sequential_preLN__sliding_local_dilated__glu_gated_geglu__prompt'

def setup_inputs():

    _w = (lambda a: (lambda t: t.to(torch.bfloat16) if t.is_floating_point() else t)(torch.as_tensor(a)))
    def _A_setup():
        B, S, D = 1, 2048, 512
        return {
            "x": _w((lambda *s: torch.randn(*s, dtype=torch.bfloat16) * 0.05)(B, S, D)),
            "wqkv": _w((lambda *s: torch.randn(*s, dtype=torch.bfloat16) * 0.05)(D, 3 * D)),
            "wo": _w((lambda *s: torch.randn(*s, dtype=torch.bfloat16) * 0.05)(D, D)),
        }
    _A_in = _A_setup()

    def _B_setup():
        B, S, Dm, Df = 1, 2048, 512, 1792
        return {
            "x": _w((lambda *s: torch.randn(*s, dtype=torch.bfloat16) * 0.05)(B, S, Dm)),
            "w_gate": _w((lambda *s: torch.randn(*s, dtype=torch.bfloat16) * 0.8)(Dm, Df) * (Dm ** -0.5)),
            "w_up": _w((lambda *s: torch.randn(*s, dtype=torch.bfloat16) * 0.8)(Dm, Df) * (Dm ** -0.5)),
            "w_down": _w((lambda *s: torch.randn(*s, dtype=torch.bfloat16) * 0.8)(Df, Dm) * (Df ** -0.5)),
        }
    _B_in = _B_setup()

    return {
        "A_x": _A_in["x"],
        "A_wqkv": _A_in["wqkv"],
        "A_wo": _A_in["wo"],
        "B_x": _B_in["x"],
        "B_w_gate": _B_in["w_gate"],
        "B_w_up": _B_in["w_up"],
        "B_w_down": _B_in["w_down"],
    }

def reference(A_x, A_wqkv, A_wo, B_x, B_w_gate, B_w_up, B_w_down):
    def _A_ref(x, wqkv, wo):
        B, S, D = x.shape
        H = 32; Dh = D // H
        W, dil = 8, 2
        qkv = (lambda x, *d: x.permute(*d))((x @ wqkv).reshape(B, S, 3, H, Dh), 2, 0, 3, 1, 4)
        q, k, v = qkv[0], qkv[1], qkv[2]
        scale = Dh ** -0.5
        pos = torch.arange(S)
        off = torch.arange(W) * dil
        idx = pos[:, None] - off[None, :]
        mask = idx >= 0
        idx_c = torch.where(mask, idx, 0).reshape(-1)
        kg = k[:, :, idx_c, :].reshape(B, H, S, W, Dh)
        vg = v[:, :, idx_c, :].reshape(B, H, S, W, Dh)
        logits = torch.einsum("bhsd,bhswd->bhsw", q, kg) * scale
        logits = torch.where(mask[None, None, :, :], logits, -1e9)
        attn = _softmax(logits, axis=-1)
        o = torch.einsum("bhsw,bhswd->bhsd", attn, vg)
        return (lambda x, *d: x.permute(*d))(o, 0, 2, 1, 3).reshape(B, S, D) @ wo

    def _B_ref(x, w_gate, w_up, w_down):
        g = torch.einsum("bsd,df->bsf", x, w_gate)
        u = torch.einsum("bsd,df->bsf", x, w_up)
        h = _gelu(g) * u
        return torch.einsum("bsf,fd->bsd", h, w_down)

    x = A_x
    h = x + _A_ref(_layernorm(x, axis=-1), A_wqkv, A_wo)
    h2 = h + _B_ref(_layernorm(h, axis=-1), B_w_gate, B_w_up, B_w_down)
    return h2
```

```asm
; @launch grid=(256,1,1) block=(768,1,1) lds=163840
.amdgcn_target "amdgcn-amd-amdhsa--gfx950"
.text
.globl sequential_preLN__sliding_local_dilated__glu_gated_geglu__prompt_kernel
.p2align 8
.type sequential_preLN__sliding_local_dilated__glu_gated_geglu__prompt_kernel,@function
sequential_preLN__sliding_local_dilated__glu_gated_geglu__prompt_kernel:
    s_cmp_ge_u32 s2, 256
    s_cbranch_scc1 L_end
    s_load_dwordx8 s[84:91], s[0:1], 0
    s_load_dwordx8 s[92:99], s[0:1], 32
    s_load_dwordx4 s[80:83], s[0:1], 64
    s_memrealtime s[100:101]
    v_and_b32 v1, 63, v0
    v_lshrrev_b32 v2, 6, v0
    s_nop 0
    v_readfirstlane_b32 s20, v2
    s_nop 0
    s_cmp_lg_u32 s20, 1
    s_cbranch_scc1 L_sequential_preLN__sliding_local_dilated__glu_gated_geglu__prompt_kernel_nocp_1
    s_getpc_b64 s[60:61]
    s_and_b32 s60, s60, 0xffffff00
    s_sub_u32 s60, s60, 0x0
    s_subb_u32 s61, s61, 0
    s_lshr_b32 s24, s2, 3
    s_min_u32 s24, s24, 19
    s_lshl_b32 s24, s24, 10
    v_lshlrev_b32 v5, 4, v1
    v_add_u32 v5, s24, v5
    global_load_dwordx4 v[164:167], v5, s[60:61]
L_sequential_preLN__sliding_local_dilated__glu_gated_geglu__prompt_kernel_nocp_1:
    s_and_b32 s3, s2, 7
    s_lshr_b32 s23, s2, 3
    s_and_b32 s21, s3, 3
    s_lshr_b32 s22, s3, 2
    s_lshl_b32 s74, s21, 2
    s_lshr_b32 s24, s23, 3
    s_add_u32 s74, s74, s24
    s_and_b32 s24, s23, 7
    s_lshl_b32 s76, s74, 1
    s_and_b32 s25, s24, 1
    s_add_u32 s76, s76, s25
    s_lshl_b32 s77, s22, 2
    s_lshr_b32 s25, s24, 1
    s_add_u32 s77, s77, s25
    s_lshl_b32 s75, s22, 3
    s_add_u32 s75, s75, s24
    s_sub_u32 s21, s20, 8
    s_mov_b32 s78, 0
    s_waitcnt lgkmcnt(0)
    s_add_u32 s64, s82, 12582912
    s_addc_u32 s65, s83, 0
    s_mov_b32 s66, 1048576
    s_mov_b32 s67, 0x00020000
    s_mov_b32 s68, s80
    s_mov_b32 s69, s81
    s_mov_b32 s70, 256
    s_mov_b32 s71, 0x00020000
    s_or_b32 s24, s2, s20
    s_cmp_lg_u32 s24, 0
    s_cbranch_scc1 L_sequential_preLN__sliding_local_dilated__glu_gated_geglu__prompt_kernel_nonce_2
    s_or_b32 s100, s100, 1
    v_mov_b32 v2, 0
    v_mov_b32 v3, s100
    buffer_store_dword v3, v2, s[68:71], 0 offen sc1
L_sequential_preLN__sliding_local_dilated__glu_gated_geglu__prompt_kernel_nonce_2:
    s_cmp_lt_u32 s20, 8
    s_cbranch_scc1 L_sequential_preLN__sliding_local_dilated__glu_gated_geglu__prompt_kernel_compute_3
    s_setprio 3
    s_lshl_b32 s25, s76, 6
    s_sub_u32 s25, s25, 16
    s_lshl_b32 s26, s77, 7
    v_lshrrev_b32 v3, 3, v1
    v_and_b32 v4, 7, v1
    s_mul_i32 s24, s21, 20
    v_add_u32 v5, s24, v3
    s_lshl_b32 s30, s24, 7
    s_cmp_eq_u32 s21, 0
    s_cselect_b32 s31, 0xffffff00, -1
    v_bfe_u32 v6, v5, 1, 3
    v_xor_b32 v6, v6, v4
    v_add_u32 v7, s25, v5
    v_max_i32 v7, 0, v7
    v_lshlrev_b32 v7, 10, v7
    v_lshl_add_u32 v10, v6, 4, v7
    v_add_u32 v5, 8, v5
    v_bfe_u32 v6, v5, 1, 3
    v_xor_b32 v6, v6, v4
    v_add_u32 v7, s25, v5
    v_max_i32 v7, 0, v7
    v_lshlrev_b32 v7, 10, v7
    v_lshl_add_u32 v11, v6, 4, v7
    v_add_u32 v5, 8, v5
    v_bfe_u32 v6, v5, 1, 3
    v_xor_b32 v6, v6, v4
    v_add_u32 v7, s25, v5
    v_max_i32 v7, 0, v7
    v_lshlrev_b32 v7, 10, v7
    v_lshl_add_u32 v12, v6, 4, v7
    s_mov_b32 s4, s84
    s_mov_b32 s5, s85
    s_mov_b32 s6, 2097152
    s_mov_b32 s7, 0x00020000
    s_mov_b32 s8, s86
    s_mov_b32 s9, s87
    s_mov_b32 s10, 1572864
    s_mov_b32 s11, 0x00020000
    s_add_u32 s46, s30, 0
    s_movk_i32 s36, 0
    s_mul_i32 s24, s21, 384
    v_add_u32 v5, s24, v1
    s_mul_i32 s32, s21, 6144
    s_add_u32 s32, s32, 10240
    v_mul_u32_u24 v6, 2731, v5
    s_mov_b32 m0, s46
    s_mov_b32 exec_lo, s31
    buffer_load_dwordx4 v10, s[4:7], s36 offen lds
    s_mov_b32 exec_lo, -1
    v_lshrrev_b32 v6, 16, v6
    v_mul_u32_u24 v7, 24, v6
    v_sub_u32 v7, v5, v7
    v_lshrrev_b32 v8, 1, v7
    v_and_b32 v7, 1, v7
    v_bfe_u32 v9, v6, 1, 1
    s_add_u32 m0, s46, 1024
    s_nop 0
    buffer_load_dwordx4 v11, s[4:7], s36 offen lds
    v_lshrrev_b32 v2, 2, v6
    v_and_b32 v2, 2, v2
    v_or_b32 v9, v9, v2
    v_xor_b32 v9, v8, v9
    v_and_b32 v9, 3, v9
    s_add_u32 m0, s46, 2048
    s_mov_b32 exec_hi, 0
    buffer_load_dwordx4 v12, s[4:7], s36 offen lds
    s_mov_b32 exec_hi, -1
    v_lshrrev_b32 v8, 2, v8
    v_mul_u32_u24 v6, 3072, v6
    v_lshl_add_u32 v6, v8, 10, v6
    v_lshl_add_u32 v6, v9, 5, v6
    v_lshl_add_u32 v6, v7, 4, v6
    v_add_u32 v13, s26, v6
    s_add_u32 s46, s30, 34816
    s_movk_i32 s36, 128
    v_xor_b32 v6, 64, v13
    v_add_u32 v16, 24576, v6
    v_add_u32 v5, 64, v5
    v_mul_u32_u24 v6, 2731, v5
    v_lshrrev_b32 v6, 16, v6
    s_mov_b32 m0, s46
    s_mov_b32 exec_lo, s31
    buffer_load_dwordx4 v10, s[4:7], s36 offen lds
    s_mov_b32 exec_lo, -1
    v_mul_u32_u24 v7, 24, v6
    v_sub_u32 v7, v5, v7
    v_lshrrev_b32 v8, 1, v7
    v_and_b32 v7, 1, v7
    v_bfe_u32 v9, v6, 1, 1
    v_lshrrev_b32 v2, 2, v6
    s_add_u32 m0, s46, 1024
    s_nop 0
    buffer_load_dwordx4 v11, s[4:7], s36 offen lds
    v_and_b32 v2, 2, v2
    v_or_b32 v9, v9, v2
    v_xor_b32 v9, v8, v9
    v_and_b32 v9, 3, v9
    v_lshrrev_b32 v8, 2, v8
    s_add_u32 m0, s46, 2048
    s_mov_b32 exec_hi, 0
    buffer_load_dwordx4 v12, s[4:7], s36 offen lds
    s_mov_b32 exec_hi, -1
    v_mul_u32_u24 v6, 3072, v6
    v_lshl_add_u32 v6, v8, 10, v6
    v_lshl_add_u32 v6, v9, 5, v6
    v_lshl_add_u32 v6, v7, 4, v6
    v_add_u32 v14, s26, v6
    v_xor_b32 v6, 64, v14
    s_add_u32 s46, s30, 69632
    s_movk_i32 s36, 256
    v_add_u32 v17, 24576, v6
    v_add_u32 v5, 64, v5
    v_mul_u32_u24 v6, 2731, v5
    v_lshrrev_b32 v6, 16, v6
    v_mul_u32_u24 v7, 24, v6
    s_mov_b32 m0, s46
    s_mov_b32 exec_lo, s31
    buffer_load_dwordx4 v10, s[4:7], s36 offen lds
    s_mov_b32 exec_lo, -1
    v_sub_u32 v7, v5, v7
    v_lshrrev_b32 v8, 1, v7
    v_and_b32 v7, 1, v7
    v_bfe_u32 v9, v6, 1, 1
    v_lshrrev_b32 v2, 2, v6
    v_and_b32 v2, 2, v2
    s_add_u32 m0, s46, 1024
    s_nop 0
    buffer_load_dwordx4 v11, s[4:7], s36 offen lds
    v_or_b32 v9, v9, v2
    v_xor_b32 v9, v8, v9
    v_and_b32 v9, 3, v9
    v_lshrrev_b32 v8, 2, v8
    v_mul_u32_u24 v6, 3072, v6
    s_add_u32 m0, s46, 2048
    s_mov_b32 exec_hi, 0
    buffer_load_dwordx4 v12, s[4:7], s36 offen lds
    s_mov_b32 exec_hi, -1
    v_lshl_add_u32 v6, v8, 10, v6
    v_lshl_add_u32 v6, v9, 5, v6
    v_lshl_add_u32 v6, v7, 4, v6
    v_add_u32 v15, s26, v6
    v_xor_b32 v6, 64, v15
    v_add_u32 v18, 24576, v6
    s_add_u32 s47, s32, 0
    s_mov_b32 s37, 0
    v_lshrrev_b32 v3, 3, v1
    s_add_u32 m0, s47, 0
    s_nop 0
    buffer_load_dwordx4 v13, s[8:11], s37 offen lds
    v_and_b32 v4, 7, v1
    s_add_u32 m0, s47, 1024
    s_nop 0
    buffer_load_dwordx4 v14, s[8:11], s37 offen lds
    s_lshl_b32 s24, s21, 5
    v_add_u32 v5, s24, v3
    s_add_u32 m0, s47, 2048
    s_nop 0
    buffer_load_dwordx4 v15, s[8:11], s37 offen lds
    v_bfe_u32 v6, v1, 4, 1
    s_add_u32 m0, s47, 3072
    s_nop 0
    buffer_load_dwordx4 v16, s[8:11], s37 offen lds
    v_lshlrev_b32 v6, 2, v6
    v_xor_b32 v6, v6, v4
    s_add_u32 m0, s47, 4096
    s_nop 0
    buffer_load_dwordx4 v17, s[8:11], s37 offen lds
    v_lshlrev_b32 v7, 10, v5
    s_add_u32 m0, s47, 5120
    s_nop 0
    buffer_load_dwordx4 v18, s[8:11], s37 offen lds
    v_lshl_add_u32 v7, v6, 4, v7
    v_add_u32 v20, s26, v7
    s_add_u32 s47, s32, 34816
    s_mov_b32 s37, 196608
    v_add_u32 v21, 0x2000, v20
    s_add_u32 m0, s47, 0
    s_nop 0
    buffer_load_dwordx4 v13, s[8:11], s37 offen lds
    v_add_u32 v22, 0x4000, v20
    v_add_u32 v23, 0x6000, v20
    s_add_u32 m0, s47, 1024
    s_nop 0
    buffer_load_dwordx4 v14, s[8:11], s37 offen lds
    s_lshl_b32 s40, s21, 12
    s_add_u32 m0, s47, 2048
    s_nop 0
    buffer_load_dwordx4 v15, s[8:11], s37 offen lds
    v_lshlrev_b32 v51, 4, v1
    s_mov_b32 s12, s88
    s_add_u32 m0, s47, 3072
    s_nop 0
    buffer_load_dwordx4 v16, s[8:11], s37 offen lds
    s_mov_b32 s13, s89
    s_add_u32 m0, s47, 4096
    s_nop 0
    buffer_load_dwordx4 v17, s[8:11], s37 offen lds
    s_mov_b32 s14, 524288
    s_mov_b32 s15, 0x00020000
    s_add_u32 m0, s47, 5120
    s_nop 0
    buffer_load_dwordx4 v18, s[8:11], s37 offen lds
    v_mov_b32 v80, 0
    s_add_u32 s47, s32, 69632
    s_mov_b32 s37, 393216
    v_mov_b32 v81, 0
    v_mov_b32 v82, 0
    s_add_u32 m0, s47, 0
    s_nop 0
    buffer_load_dwordx4 v13, s[8:11], s37 offen lds
    v_mov_b32 v83, 0
    s_add_u32 m0, s47, 1024
    s_nop 0
    buffer_load_dwordx4 v14, s[8:11], s37 offen lds
    v_mov_b32 v84, 0
    v_mov_b32 v85, 0
    s_add_u32 m0, s47, 2048
    s_nop 0
    buffer_load_dwordx4 v15, s[8:11], s37 offen lds
    v_mov_b32 v86, 0
    s_add_u32 m0, s47, 3072
    s_nop 0
    buffer_load_dwordx4 v16, s[8:11], s37 offen lds
    v_mov_b32 v87, 0
    v_mov_b32 v88, 0
    s_add_u32 m0, s47, 4096
    s_nop 0
    buffer_load_dwordx4 v17, s[8:11], s37 offen lds
    v_mov_b32 v89, 0
    s_add_u32 m0, s47, 5120
    s_nop 0
    buffer_load_dwordx4 v18, s[8:11], s37 offen lds
    v_mov_b32 v90, 0
    v_mov_b32 v91, 0
    s_movk_i32 s36, 384
    s_mov_b32 s37, 589824
    s_mov_b32 s33, 104448
    s_mov_b32 s38, 0
    s_mov_b32 s45, s30
    s_waitcnt vmcnt(12)
    .p2align 6
L_sequential_preLN__sliding_local_dilated__glu_gated_geglu__prompt_kernel_l1_5:
    s_waitcnt vmcnt(15)
    s_barrier
    s_add_u32 s46, s33, s30
    s_add_u32 s47, s33, s32
    s_mov_b32 m0, s46
    s_mov_b32 exec_lo, s31
    buffer_load_dwordx4 v10, s[4:7], s36 offen lds
    s_mov_b32 exec_lo, -1
    s_add_u32 m0, s46, 1024
    s_nop 0
    buffer_load_dwordx4 v11, s[4:7], s36 offen lds
    s_add_u32 m0, s46, 2048
    s_mov_b32 exec_hi, 0
    buffer_load_dwordx4 v12, s[4:7], s36 offen lds
    s_mov_b32 exec_hi, -1
    s_add_u32 m0, s47, 0
    s_nop 0
    buffer_load_dwordx4 v13, s[8:11], s37 offen lds
    s_add_u32 m0, s47, 1024
    s_nop 0
    buffer_load_dwordx4 v14, s[8:11], s37 offen lds
    s_add_u32 m0, s47, 2048
    s_nop 0
    buffer_load_dwordx4 v15, s[8:11], s37 offen lds
    s_add_u32 m0, s47, 3072
    s_nop 0
    buffer_load_dwordx4 v16, s[8:11], s37 offen lds
    s_add_u32 m0, s47, 4096
    s_nop 0
    buffer_load_dwordx4 v17, s[8:11], s37 offen lds
    s_add_u32 m0, s47, 5120
    s_nop 0
    buffer_load_dwordx4 v18, s[8:11], s37 offen lds
    s_add_u32 s36, s36, 128
    s_add_u32 s37, s37, 196608
    s_add_u32 s33, s33, 34816
    s_cmp_ge_u32 s33, 139264
    s_cselect_b32 s33, 0, s33
    s_add_u32 s38, s38, 1
    s_cmp_lt_u32 s38, 5
    s_cbranch_scc1 L_sequential_preLN__sliding_local_dilated__glu_gated_geglu__prompt_kernel_l1_5
    s_waitcnt vmcnt(18)
    s_barrier
    s_add_u32 s8, s82, 14155776
    s_addc_u32 s9, s83, 0
    s_mov_b32 s10, 32768
    s_mov_b32 s11, 0x00020000
    v_mov_b32 v2, 0
    s_mov_b32 s59, 0
    s_mul_i32 s24, s21, 20
    v_min_u32 v6, 19, v1
    v_add_u32 v6, s24, v6
    v_add_u32 v7, s25, v6
    v_max_i32 v7, 0, v7
    v_lshlrev_b32 v7, 4, v7
    v_lshlrev_b32 v6, 3, v6
    v_add_u32 v6, 139264, v6
    v_mov_b32 v44, v6
    v_mov_b32 v45, v7
    v_mov_b32 v2, 139976
    ds_read_b32 v3, v2
    buffer_load_dwordx4 v[64:67], v45, s[8:11], 0 offen sc1
    s_waitcnt lgkmcnt(0)
    v_readfirstlane_b32 s79, v3
    s_cmp_ge_u32 s21, 2
    s_cselect_b32 s16, s94, s92
    s_cselect_b32 s17, s95, s93
    s_mov_b32 s18, 1835008
    s_mov_b32 s19, 0x00020000
    s_lshr_b32 s24, s2, 3
    s_mul_i32 s24, s24, 6
    s_and_b32 s29, s21, 1
    s_mul_i32 s29, s29, 3
    s_add_u32 s24, s24, s29
    s_mul_i32 s24, s24, 3584
    s_bfe_u32 s29, s2, 0x10002
    s_mul_i32 s29, s29, 1792
    s_add_u32 s28, s24, s29
    v_add_u32 v8, 1024, v51
    v_mov_b32 v9, 0x80000000
    v_cmp_gt_u32 vcc, 48, v1
    s_nop 1
    v_cndmask_b32 v46, v9, v8, vcc
    s_waitcnt vmcnt(10)
    s_barrier
    s_mov_b32 s41, 0
    s_add_u32 s46, s40, 32768
    s_mov_b32 s42, 131072
    s_add_u32 s47, s40, 49152
    s_add_u32 m0, s46, 0
    s_nop 0
    buffer_load_dwordx4 v20, s[12:15], s41 offen lds
    s_add_u32 m0, s46, 1024
    s_nop 0
    buffer_load_dwordx4 v21, s[12:15], s41 offen lds
    s_add_u32 m0, s46, 2048
    s_nop 0
    buffer_load_dwordx4 v22, s[12:15], s41 offen lds
    s_add_u32 m0, s46, 3072
    s_nop 0
    buffer_load_dwordx4 v23, s[12:15], s41 offen lds
    s_add_u32 m0, s47, 0
    s_nop 0
    buffer_load_dwordx4 v20, s[12:15], s42 offen lds
    s_add_u32 m0, s47, 1024
    s_nop 0
    buffer_load_dwordx4 v21, s[12:15], s42 offen lds
    s_add_u32 m0, s47, 2048
    s_nop 0
    buffer_load_dwordx4 v22, s[12:15], s42 offen lds
    s_add_u32 m0, s47, 3072
    s_nop 0
    buffer_load_dwordx4 v23, s[12:15], s42 offen lds
    s_waitcnt vmcnt(9)
    s_waitcnt vmcnt(8)
L_sequential_preLN__sliding_local_dilated__glu_gated_geglu__prompt_kernel_lgetn_7:
    s_add_u32 s59, s59, 1
    s_cmp_ge_u32 s59, 400000
    s_cbranch_scc1 L_sequential_preLN__sliding_local_dilated__glu_gated_geglu__prompt_kernel_lxs_8
    v_cmp_ne_u32 vcc, s79, v66
    s_nop 0
    s_cmp_eq_u64 vcc, 0
    s_cbranch_scc1 L_sequential_preLN__sliding_local_dilated__glu_gated_geglu__prompt_kernel_lxs_8
    buffer_load_dwordx4 v[64:67], v45, s[8:11], 0 offen sc1
    s_waitcnt vmcnt(0)
    s_branch L_sequential_preLN__sliding_local_dilated__glu_gated_geglu__prompt_kernel_lgetn_7
L_sequential_preLN__sliding_local_dilated__glu_gated_geglu__prompt_kernel_lxs_8:
    v_mul_f32 v52, 989855744, v64
    v_mul_f32 v53, 989855744, v65
    v_fma_f32 v53, -v52, v52, v53
    v_max_f32 v53, 0, v53
    v_cvt_pk_bf16_f32 v54, v52, v52
    v_lshlrev_b32 v52, 16, v54
    v_cvt_pk_bf16_f32 v54, v53, v53
    v_lshlrev_b32 v53, 16, v54
    v_add_f32 v53, 925353388, v53
    v_cvt_pk_bf16_f32 v54, v53, v53
    v_lshlrev_b32 v53, 16, v54
    v_sqrt_f32 v53, v53
    s_nop 0
    v_cvt_pk_bf16_f32 v54, v53, v53
    v_lshlrev_b32 v53, 16, v54
    v_rcp_f32 v53, v53
    s_nop 0
    v_mul_f32 v52, v52, v53
    v_sub_f32 v52, 0, v52
    ds_write_b64 v44, v[52:53]
    s_waitcnt lgkmcnt(0)
    s_barrier
    s_mov_b32 s41, 262144
    s_add_u32 s46, s40, 65536
    s_mov_b32 s42, 393216
    s_add_u32 s47, s40, 81920
    s_add_u32 m0, s46, 0
    s_nop 0
    buffer_load_dwordx4 v20, s[12:15], s41 offen lds
    s_add_u32 m0, s46, 1024
    s_nop 0
    buffer_load_dwordx4 v21, s[12:15], s41 offen lds
    s_add_u32 m0, s46, 2048
    s_nop 0
    buffer_load_dwordx4 v22, s[12:15], s41 offen lds
    s_add_u32 m0, s46, 3072
    s_nop 0
    buffer_load_dwordx4 v23, s[12:15], s41 offen lds
    s_add_u32 m0, s47, 0
    s_nop 0
    buffer_load_dwordx4 v20, s[12:15], s42 offen lds
    s_add_u32 m0, s47, 1024
    s_nop 0
    buffer_load_dwordx4 v21, s[12:15], s42 offen lds
    s_add_u32 m0, s47, 2048
    s_nop 0
    buffer_load_dwordx4 v22, s[12:15], s42 offen lds
    s_add_u32 m0, s47, 3072
    s_nop 0
    buffer_load_dwordx4 v23, s[12:15], s42 offen lds
    s_barrier
    s_setprio 0
    buffer_load_dwordx4 v[128:131], v51, s[16:19], s28 offen
    buffer_load_dwordx4 v[132:135], v46, s[16:19], s28 offen
    s_add_u32 s28, s28, 3584
    buffer_load_dwordx4 v[136:139], v51, s[16:19], s28 offen
    buffer_load_dwordx4 v[140:143], v46, s[16:19], s28 offen
    s_add_u32 s28, s28, 3584
    buffer_load_dwordx4 v[144:147], v51, s[16:19], s28 offen
    buffer_load_dwordx4 v[148:151], v46, s[16:19], s28 offen
    s_add_u32 s28, s28, 3584
    v_lshrrev_b32 v3, 4, v1
    v_and_b32 v4, 15, v1
    s_lshl_b32 s24, s21, 4
    v_add_u32 v5, s24, v3
    s_lshl_b32 s25, s76, 6
    s_movk_i32 s42, 1024
    v_and_b32 v6, 15, v5
    v_xor_b32 v6, v6, v4
    v_add_u32 v7, s25, v5
    v_mul_lo_u32 v7, v7, s42
    v_lshl_add_u32 v24, v6, 4, v7
    v_add_u32 v5, 4, v5
    v_and_b32 v6, 15, v5
    v_xor_b32 v6, v6, v4
    v_add_u32 v7, s25, v5
    v_mul_lo_u32 v7, v7, s42
    v_lshl_add_u32 v25, v6, 4, v7
    v_add_u32 v5, 4, v5
    v_and_b32 v6, 15, v5
    v_xor_b32 v6, v6, v4
    v_add_u32 v7, s25, v5
    v_mul_lo_u32 v7, v7, s42
    v_lshl_add_u32 v26, v6, 4, v7
    v_add_u32 v5, 4, v5
    v_and_b32 v6, 15, v5
    v_xor_b32 v6, v6, v4
    v_add_u32 v7, s25, v5
    v_mul_lo_u32 v7, v7, s42
    v_lshl_add_u32 v27, v6, 4, v7
    s_mov_b32 s4, s82
    s_mov_b32 s5, s83
    s_mov_b32 s6, 2097152
    s_mov_b32 s7, 0x00020000
    s_and_b32 s53, s2, 1
    s_lshr_b32 s52, s2, 1
    s_and_b32 s52, s52, 15
    s_lshr_b32 s54, s2, 5
    s_cmp_eq_u32 s53, 1
    s_cselect_b32 s16, s94, s92
    s_cselect_b32 s17, s95, s93
    v_mul_u32_u24 v6, 4682, v1
    v_lshrrev_b32 v6, 16, v6
    v_mul_u32_u24 v7, 14, v6
    v_sub_u32 v7, v1, v7
    v_mul_u32_u24 v8, 3584, v6
    v_lshl_add_u32 v8, v7, 4, v8
    s_mul_i32 s24, s52, 224
    s_lshl_b32 s29, s54, 2
    s_add_u32 s29, s29, s21
    s_mul_i32 s29, s29, 57344
    s_add_u32 s24, s24, s29
    v_add_u32 v8, s24, v8
    v_mov_b32 v9, 0x80000000
    v_cmp_gt_u32 vcc, 56, v1
    s_nop 1
    v_cndmask_b32 v48, v9, v8, vcc
    s_mov_b32 s29, 0
    buffer_load_dwordx4 v[96:99], v48, s[16:19], s29 offen
    s_add_u32 s29, s29, 14336
    buffer_load_dwordx4 v[100:103], v48, s[16:19], s29 offen
    s_add_u32 s29, s29, 14336
    buffer_load_dwordx4 v[104:107], v48, s[16:19], s29 offen
    s_add_u32 s29, s29, 14336
    buffer_load_dwordx4 v[108:111], v48, s[16:19], s29 offen
    s_add_u32 s29, s29, 14336
    v_mov_b32 v112, 0
    v_mov_b32 v113, 0
    v_mov_b32 v114, 0
    v_mov_b32 v115, 0
    v_mov_b32 v116, 0
    v_mov_b32 v117, 0
    v_mov_b32 v118, 0
    v_mov_b32 v119, 0
    s_waitcnt vmcnt(3)
    v_lshlrev_b32 v52, 16, v96
    v_and_b32 v53, 0xffff0000, v96
    v_add_f32 v112, v112, v52
    v_add_f32 v113, v113, v53
    v_lshlrev_b32 v54, 16, v97
    v_and_b32 v55, 0xffff0000, v97
    v_add_f32 v114, v114, v54
    v_add_f32 v115, v115, v55
    v_lshlrev_b32 v52, 16, v98
    v_and_b32 v53, 0xffff0000, v98
    v_add_f32 v116, v116, v52
    v_add_f32 v117, v117, v53
    v_lshlrev_b32 v54, 16, v99
    v_and_b32 v55, 0xffff0000, v99
    v_add_f32 v118, v118, v54
    v_add_f32 v119, v119, v55
    s_waitcnt vmcnt(2)
    v_lshlrev_b32 v52, 16, v100
    v_and_b32 v53, 0xffff0000, v100
    v_add_f32 v112, v112, v52
    v_add_f32 v113, v113, v53
    v_lshlrev_b32 v54, 16, v101
    v_and_b32 v55, 0xffff0000, v101
    v_add_f32 v114, v114, v54
    v_add_f32 v115, v115, v55
    v_lshlrev_b32 v52, 16, v102
    v_and_b32 v53, 0xffff0000, v102
    v_add_f32 v116, v116, v52
    v_add_f32 v117, v117, v53
    v_lshlrev_b32 v54, 16, v103
    v_and_b32 v55, 0xffff0000, v103
    v_add_f32 v118, v118, v54
    v_add_f32 v119, v119, v55
    s_waitcnt vmcnt(1)
    v_lshlrev_b32 v52, 16, v104
    v_and_b32 v53, 0xffff0000, v104
    v_add_f32 v112, v112, v52
    v_add_f32 v113, v113, v53
    v_lshlrev_b32 v54, 16, v105
    v_and_b32 v55, 0xffff0000, v105
    v_add_f32 v114, v114, v54
    v_add_f32 v115, v115, v55
    v_lshlrev_b32 v52, 16, v106
    v_and_b32 v53, 0xffff0000, v106
    v_add_f32 v116, v116, v52
    v_add_f32 v117, v117, v53
    v_lshlrev_b32 v54, 16, v107
    v_and_b32 v55, 0xffff0000, v107
    v_add_f32 v118, v118, v54
    v_add_f32 v119, v119, v55
    s_waitcnt vmcnt(0)
    v_lshlrev_b32 v52, 16, v108
    v_and_b32 v53, 0xffff0000, v108
    v_add_f32 v112, v112, v52
    v_add_f32 v113, v113, v53
    v_lshlrev_b32 v54, 16, v109
    v_and_b32 v55, 0xffff0000, v109
    v_add_f32 v114, v114, v54
    v_add_f32 v115, v115, v55
    v_lshlrev_b32 v52, 16, v110
    v_and_b32 v53, 0xffff0000, v110
    v_add_f32 v116, v116, v52
    v_add_f32 v117, v117, v53
    v_lshlrev_b32 v54, 16, v111
    v_and_b32 v55, 0xffff0000, v111
    v_add_f32 v118, v118, v54
    v_add_f32 v119, v119, v55
    v_add_u32 v50, 14, v1
    v_lshlrev_b32 v50, 2, v50
    v_add_u32 v49, 28, v1
    v_lshlrev_b32 v49, 2, v49
    ds_bpermute_b32 v64, v50, v112
    ds_bpermute_b32 v65, v50, v113
    ds_bpermute_b32 v66, v50, v114
    ds_bpermute_b32 v67, v50, v115
    ds_bpermute_b32 v68, v50, v116
    ds_bpermute_b32 v69, v50, v117
    ds_bpermute_b32 v70, v50, v118
    ds_bpermute_b32 v71, v50, v119
    s_waitcnt lgkmcnt(0)
    v_add_f32 v112, v112, v64
    v_add_f32 v113, v113, v65
    v_add_f32 v114, v114, v66
    v_add_f32 v115, v115, v67
    v_add_f32 v116, v116, v68
    v_add_f32 v117, v117, v69
    v_add_f32 v118, v118, v70
    v_add_f32 v119, v119, v71
    ds_bpermute_b32 v64, v49, v112
    ds_bpermute_b32 v65, v49, v113
    ds_bpermute_b32 v66, v49, v114
    ds_bpermute_b32 v67, v49, v115
    ds_bpermute_b32 v68, v49, v116
    ds_bpermute_b32 v69, v49, v117
    ds_bpermute_b32 v70, v49, v118
    ds_bpermute_b32 v71, v49, v119
    s_waitcnt lgkmcnt(0)
    v_add_f32 v112, v112, v64
    v_add_f32 v113, v113, v65
    v_add_f32 v114, v114, v66
    v_add_f32 v115, v115, v67
    v_add_f32 v116, v116, v68
    v_add_f32 v117, v117, v69
    v_add_f32 v118, v118, v70
    v_add_f32 v119, v119, v71
    s_add_u32 s16, s82, 13631488
    s_addc_u32 s17, s83, 0
    s_mov_b32 s18, 262144
    s_mov_b32 s19, 0x00020000
    s_barrier
    s_setprio 3
    s_movk_i32 s43, 0
    s_add_u32 s46, s40, 98304
    s_mul_i32 s26, s75, 224
    v_mov_b32 v5, v1
    v_mul_u32_u24 v6, 4682, v5
    v_lshrrev_b32 v6, 16, v6
    v_mul_u32_u24 v7, 14, v6
    s_add_u32 m0, s46, 0
    s_nop 0
    buffer_load_dwordx4 v24, s[4:7], s43 offen sc1 lds
    v_sub_u32 v7, v5, v7
    v_mul_u32_u24 v6, 3584, v6
    v_lshl_add_u32 v6, v7, 4, v6
    v_add_u32 v30, s26, v6
    v_add_u32 v5, 64, v5
    s_add_u32 m0, s46, 1024
    s_nop 0
    buffer_load_dwordx4 v25, s[4:7], s43 offen sc1 lds
    v_mul_u32_u24 v6, 4682, v5
    v_lshrrev_b32 v6, 16, v6
    v_mul_u32_u24 v7, 14, v6
    v_sub_u32 v7, v5, v7
    v_mul_u32_u24 v6, 3584, v6
    v_lshl_add_u32 v6, v7, 4, v6
    s_add_u32 m0, s46, 2048
    s_nop 0
    buffer_load_dwordx4 v26, s[4:7], s43 offen sc1 lds
    v_add_u32 v31, s26, v6
    v_add_u32 v5, 64, v5
    v_mul_u32_u24 v6, 4682, v5
    v_lshrrev_b32 v6, 16, v6
    v_mul_u32_u24 v7, 14, v6
    s_add_u32 m0, s46, 3072
    s_nop 0
    buffer_load_dwordx4 v27, s[4:7], s43 offen sc1 lds
    v_sub_u32 v7, v5, v7
    v_mul_u32_u24 v6, 3584, v6
    v_lshl_add_u32 v6, v7, 4, v6
    v_add_u32 v32, s26, v6
    v_add_u32 v5, 64, v5
    s_movk_i32 s43, 256
    s_add_u32 s46, s40, 114688
    v_mul_u32_u24 v6, 4682, v5
    v_lshrrev_b32 v6, 16, v6
    v_mul_u32_u24 v7, 14, v6
    v_sub_u32 v7, v5, v7
    v_mul_u32_u24 v6, 3584, v6
    v_lshl_add_u32 v6, v7, 4, v6
    s_add_u32 m0, s46, 0
    s_nop 0
    buffer_load_dwordx4 v24, s[4:7], s43 offen sc1 lds
    v_add_u32 v33, s26, v6
    v_add_u32 v5, 64, v5
    v_mul_u32_u24 v6, 4682, v5
    v_lshrrev_b32 v6, 16, v6
    v_mul_u32_u24 v7, 14, v6
    s_add_u32 m0, s46, 1024
    s_nop 0
    buffer_load_dwordx4 v25, s[4:7], s43 offen sc1 lds
    v_sub_u32 v7, v5, v7
    v_mul_u32_u24 v6, 3584, v6
    v_lshl_add_u32 v6, v7, 4, v6
    v_add_u32 v34, s26, v6
    v_add_u32 v5, 64, v5
    s_add_u32 m0, s46, 2048
    s_nop 0
    buffer_load_dwordx4 v26, s[4:7], s43 offen sc1 lds
    v_mul_u32_u24 v6, 4682, v5
    v_lshrrev_b32 v6, 16, v6
    v_mul_u32_u24 v7, 14, v6
    v_sub_u32 v7, v5, v7
    v_mul_u32_u24 v6, 3584, v6
    v_lshl_add_u32 v6, v7, 4, v6
    s_add_u32 m0, s46, 3072
    s_nop 0
    buffer_load_dwordx4 v27, s[4:7], s43 offen sc1 lds
    v_add_u32 v35, s26, v6
    v_add_u32 v5, 64, v5
    v_mul_u32_u24 v6, 4682, v5
    v_lshrrev_b32 v6, 16, v6
    v_mul_u32_u24 v7, 14, v6
    s_movk_i32 s43, 512
    s_add_u32 s46, s40, 131072
    v_sub_u32 v7, v5, v7
    v_mul_u32_u24 v6, 3584, v6
    v_lshl_add_u32 v6, v7, 4, v6
    v_add_u32 v36, s26, v6
    s_cmp_ge_u32 s21, 2
    s_cselect_b32 s8, s94, s92
    s_cselect_b32 s9, s95, s93
    s_mov_b32 s10, 1835008
    s_mov_b32 s11, 0x00020000
    s_cselect_b32 s44, 14464, 0
    s_add_u32 m0, s46, 0
    s_nop 0
    buffer_load_dwordx4 v24, s[4:7], s43 offen sc1 lds
    s_and_b32 s24, s21, 1
    s_mul_i32 s45, s24, 7168
    s_add_u32 s44, s44, s45
    s_add_u32 s44, s44, 57344
    s_mul_i32 s41, s24, 114688
    v_lshrrev_b32 v3, 3, v1
    s_add_u32 m0, s46, 1024
    s_nop 0
    buffer_load_dwordx4 v25, s[4:7], s43 offen sc1 lds
    v_and_b32 v4, 7, v1
    s_lshl_b32 s24, s21, 5
    v_add_u32 v5, s24, v3
    s_lshl_b32 s25, s74, 7
    v_bfe_u32 v6, v5, 1, 3
    s_add_u32 m0, s46, 2048
    s_nop 0
    buffer_load_dwordx4 v26, s[4:7], s43 offen sc1 lds
    v_xor_b32 v6, v6, v4
    v_add_u32 v7, s25, v5
    v_lshlrev_b32 v7, 10, v7
    v_lshl_add_u32 v40, v6, 4, v7
    v_add_u32 v5, 8, v5
    s_add_u32 m0, s46, 3072
    s_nop 0
    buffer_load_dwordx4 v27, s[4:7], s43 offen sc1 lds
    v_bfe_u32 v6, v5, 1, 3
    v_xor_b32 v6, v6, v4
    v_add_u32 v7, s25, v5
    v_lshlrev_b32 v7, 10, v7
    v_lshl_add_u32 v41, v6, 4, v7
    v_add_u32 v5, 8, v5
    s_movk_i32 s43, 768
    s_add_u32 s46, s40, 147456
    v_bfe_u32 v6, v5, 1, 3
    v_xor_b32 v6, v6, v4
    v_add_u32 v7, s25, v5
    v_lshlrev_b32 v7, 10, v7
    v_lshl_add_u32 v42, v6, 4, v7
    s_add_u32 m0, s46, 0
    s_nop 0
    buffer_load_dwordx4 v24, s[4:7], s43 offen sc1 lds
    v_add_u32 v5, 8, v5
    v_bfe_u32 v6, v5, 1, 3
    v_xor_b32 v6, v6, v4
    v_add_u32 v7, s25, v5
    v_lshlrev_b32 v7, 10, v7
    s_add_u32 m0, s46, 1024
    s_nop 0
    buffer_load_dwordx4 v25, s[4:7], s43 offen sc1 lds
    v_lshl_add_u32 v43, v6, 4, v7
    v_mov_b32 v80, 0
    v_mov_b32 v81, 0
    v_mov_b32 v82, 0
    v_mov_b32 v83, 0
    v_mov_b32 v84, 0
    s_add_u32 m0, s46, 2048
    s_nop 0
    buffer_load_dwordx4 v26, s[4:7], s43 offen sc1 lds
    v_mov_b32 v85, 0
    v_mov_b32 v86, 0
    v_mov_b32 v87, 0
    v_mov_b32 v88, 0
    v_mov_b32 v89, 0
    s_add_u32 m0, s46, 3072
    s_nop 0
    buffer_load_dwordx4 v27, s[4:7], s43 offen sc1 lds
    v_mov_b32 v90, 0
    v_mov_b32 v91, 0
    v_mov_b32 v92, 0
    v_mov_b32 v93, 0
    v_mov_b32 v94, 0
    v_mov_b32 v95, 0
    v_min_u32 v50, 15, v1
    v_lshlrev_b32 v50, 5, v50
    s_lshl_b32 s24, s21, 9
    s_add_u32 s24, s24, 1024
    v_add_u32 v50, s24, v50
    v_cmp_gt_u32 vcc, 14, v1
    s_nop 0
    s_and_saveexec_b64 s[60:61], vcc
    ds_write_b128 v50, v[112:115]
    ds_write_b128 v50, v[116:119] offset:16
    s_mov_b64 exec, s[60:61]
    s_waitcnt vmcnt(12) lgkmcnt(0)
    s_barrier
    s_cmp_lg_u32 s21, 0
    s_cbranch_scc1 L_sequential_preLN__sliding_local_dilated__glu_gated_geglu__prompt_kernel_csj0_9
    v_min_u32 v50, 31, v1
    v_lshlrev_b32 v50, 4, v50
    ds_read_b128 v[96:99], v50 offset:1024
    ds_read_b128 v[100:103], v50 offset:1536
    ds_read_b128 v[104:107], v50 offset:2048
    ds_read_b128 v[108:111], v50 offset:2560
    s_lshl_b32 s48, s52, 4
    s_lshl_b32 s49, s53, 3
    s_add_u32 s49, s49, s54
    s_add_u32 s48, s48, s49
    s_lshl_b32 s48, s48, 9
    v_add_u32 v8, s48, v51
    v_mov_b32 v9, 0x80000000
    v_cmp_gt_u32 vcc, 28, v1
    s_nop 1
    v_cndmask_b32 v8, v9, v8, vcc
    s_waitcnt lgkmcnt(0)
    v_add_f32 v96, v96, v100
    v_add_f32 v97, v97, v101
    v_add_f32 v98, v98, v102
    v_add_f32 v99, v99, v103
    v_add_f32 v96, v96, v104
    v_add_f32 v97, v97, v105
    v_add_f32 v98, v98, v106
    v_add_f32 v99, v99, v107
    v_add_f32 v96, v96, v108
    v_add_f32 v97, v97, v109
    v_add_f32 v98, v98, v110
    v_add_f32 v99, v99, v111
    buffer_store_dwordx4 v[96:99], v8, s[16:19], 0 offen sc1
L_sequential_preLN__sliding_local_dilated__glu_gated_geglu__prompt_kernel_csj0_9:
    s_waitcnt vmcnt(8)
    s_barrier
    s_waitcnt vmcnt(4)
    s_barrier
    s_waitcnt vmcnt(0)
    s_barrier
    s_cmp_lg_u32 s21, 0
    s_cbranch_scc1 L_sequential_preLN__sliding_local_dilated__glu_gated_geglu__prompt_kernel_csj1_10
    s_lshl_b32 s47, s52, 7
    s_add_u32 s47, s47, 24576
    s_lshl_b32 s49, s49, 2
    s_add_u32 s47, s47, s49
    s_lshl_b32 s47, s47, 5
    v_mov_b32 v2, s47
    v_mov_b32 v3, s79
    buffer_store_dword v3, v2, s[64:67], 0 offen sc1
L_sequential_preLN__sliding_local_dilated__glu_gated_geglu__prompt_kernel_csj1_10:
    s_barrier
    s_setprio 0
    v_mov_b32 v2, 40960
L_sequential_preLN__sliding_local_dilated__glu_gated_geglu__prompt_kernel_waitc2_11:
    ds_read_b32 v3, v2
    s_waitcnt lgkmcnt(0)
    v_readfirstlane_b32 s59, v3
    s_nop 0
    s_cmp_lt_u32 s59, 8
    s_cbranch_scc1 L_sequential_preLN__sliding_local_dilated__glu_gated_geglu__prompt_kernel_waitc2_11
    s_add_u32 s46, s44, 0
    s_add_u32 m0, s46, 0
    s_nop 0
    buffer_load_dwordx4 v30, s[8:11], s41 offen lds
    s_add_u32 m0, s46, 1024
    s_nop 0
    buffer_load_dwordx4 v31, s[8:11], s41 offen lds
    s_add_u32 m0, s46, 2048
    s_nop 0
    buffer_load_dwordx4 v32, s[8:11], s41 offen lds
    s_add_u32 m0, s46, 3072
    s_nop 0
    buffer_load_dwordx4 v33, s[8:11], s41 offen lds
    s_add_u32 m0, s46, 4096
    s_nop 0
    buffer_load_dwordx4 v34, s[8:11], s41 offen lds
    s_add_u32 m0, s46, 5120
    s_nop 0
    buffer_load_dwordx4 v35, s[8:11], s41 offen lds
    s_add_u32 m0, s46, 6144
    s_nop 0
    buffer_load_dwordx4 v36, s[8:11], s41 offen lds
    s_add_u32 s41, s41, 229376
    s_add_u32 s46, s44, 28800
    s_add_u32 m0, s46, 0
    s_nop 0
    buffer_load_dwordx4 v30, s[8:11], s41 offen lds
    s_add_u32 m0, s46, 1024
    s_nop 0
    buffer_load_dwordx4 v31, s[8:11], s41 offen lds
    s_add_u32 m0, s46, 2048
    s_nop 0
    buffer_load_dwordx4 v32, s[8:11], s41 offen lds
    s_add_u32 m0, s46, 3072
    s_nop 0
    buffer_load_dwordx4 v33, s[8:11], s41 offen lds
    s_add_u32 m0, s46, 4096
    s_nop 0
    buffer_load_dwordx4 v34, s[8:11], s41 offen lds
    s_add_u32 m0, s46, 5120
    s_nop 0
    buffer_load_dwordx4 v35, s[8:11], s41 offen lds
    s_add_u32 m0, s46, 6144
    s_nop 0
    buffer_load_dwordx4 v36, s[8:11], s41 offen lds
    s_add_u32 s41, s41, 229376
    s_add_u32 s4, s82, 2097152
    s_addc_u32 s5, s83, 0
    s_mov_b32 s6, 2097152
    s_mov_b32 s7, 0x00020000
    s_barrier
    s_setprio 3
    s_mov_b32 s43, 0
    s_add_u32 s45, s40, 8192
    s_add_u32 s46, s45, 0
    s_add_u32 m0, s46, 0
    s_nop 0
    buffer_load_dwordx4 v40, s[4:7], s43 offen sc1 lds
    s_add_u32 m0, s46, 1024
    s_nop 0
    buffer_load_dwordx4 v41, s[4:7], s43 offen sc1 lds
    s_add_u32 m0, s46, 2048
    s_nop 0
    buffer_load_dwordx4 v42, s[4:7], s43 offen sc1 lds
    s_add_u32 m0, s46, 3072
    s_nop 0
    buffer_load_dwordx4 v43, s[4:7], s43 offen sc1 lds
    s_add_u32 s43, s43, 128
    s_add_u32 s46, s45, 16384
    s_add_u32 m0, s46, 0
    s_nop 0
    buffer_load_dwordx4 v40, s[4:7], s43 offen sc1 lds
    s_add_u32 m0, s46, 1024
    s_nop 0
    buffer_load_dwordx4 v41, s[4:7], s43 offen sc1 lds
    s_add_u32 m0, s46, 2048
    s_nop 0
    buffer_load_dwordx4 v42, s[4:7], s43 offen sc1 lds
    s_add_u32 m0, s46, 3072
    s_nop 0
    buffer_load_dwordx4 v43, s[4:7], s43 offen sc1 lds
    s_add_u32 s43, s43, 128
    s_add_u32 s46, s45, 32768
    s_add_u32 m0, s46, 0
    s_nop 0
    buffer_load_dwordx4 v40, s[4:7], s43 offen sc1 lds
    s_add_u32 m0, s46, 1024
    s_nop 0
    buffer_load_dwordx4 v41, s[4:7], s43 offen sc1 lds
    s_add_u32 m0, s46, 2048
    s_nop 0
    buffer_load_dwordx4 v42, s[4:7], s43 offen sc1 lds
    s_add_u32 m0, s46, 3072
    s_nop 0
    buffer_load_dwordx4 v43, s[4:7], s43 offen sc1 lds
    s_add_u32 s43, s43, 128
    s_add_u32 s46, s44, 57600
    s_add_u32 m0, s46, 0
    s_nop 0
    buffer_load_dwordx4 v30, s[8:11], s41 offen lds
    s_add_u32 m0, s46, 1024
    s_nop 0
    buffer_load_dwordx4 v31, s[8:11], s41 offen lds
    s_add_u32 m0, s46, 2048
    s_nop 0
    buffer_load_dwordx4 v32, s[8:11], s41 offen lds
    s_add_u32 m0, s46, 3072
    s_nop 0
    buffer_load_dwordx4 v33, s[8:11], s41 offen lds
    s_add_u32 m0, s46, 4096
    s_nop 0
    buffer_load_dwordx4 v34, s[8:11], s41 offen lds
    s_add_u32 m0, s46, 5120
    s_nop 0
    buffer_load_dwordx4 v35, s[8:11], s41 offen lds
    s_add_u32 m0, s46, 6144
    s_nop 0
    buffer_load_dwordx4 v36, s[8:11], s41 offen lds
    s_add_u32 s41, s41, 229376
    s_mov_b32 s48, s45
    s_mov_b32 s12, s96
    s_mov_b32 s13, s97
    s_mov_b32 s14, 1835008
    s_mov_b32 s15, 0x00020000
    v_lshrrev_b32 v6, 5, v1
    v_and_b32 v7, 31, v1
    v_lshlrev_b32 v7, 4, v7
    v_lshl_add_u32 v47, v6, 10, v7
    s_lshr_b32 s24, s2, 3
    s_mul_i32 s24, s24, 56
    s_mul_i32 s29, s21, 14
    s_add_u32 s24, s24, s29
    s_lshl_b32 s24, s24, 10
    s_bfe_u32 s29, s2, 0x10002
    s_lshl_b32 s29, s29, 9
    s_add_u32 s50, s24, s29
    s_waitcnt vmcnt(15)
    s_barrier
    s_add_u32 s52, s82, 14417920
    s_addc_u32 s53, s83, 0
    s_mov_b32 s54, 131072
    s_mov_b32 s55, 0x00020000
    s_lshl_b32 s24, s74, 7
    s_lshl_b32 s29, s21, 5
    s_add_u32 s24, s24, s29
    s_lshl_b32 s24, s24, 6
    v_add_u32 v6, s24, v51
    buffer_load_dwordx4 v[64:67], v6, s[52:55], 0 offen sc1
    buffer_load_dwordx4 v[68:71], v6, s[52:55], 0 offen offset:1024 sc1
    s_lshl_b32 s46, s75, 4
    s_and_b32 s49, s21, 1
    s_lshl_b32 s49, s49, 3
    s_add_u32 s46, s46, s49
    s_lshl_b32 s46, s46, 9
    v_lshlrev_b32 v8, 4, v1
    v_add_u32 v8, s46, v8
    v_mov_b32 v9, 0x80000000
    v_cmp_gt_u32 vcc, 28, v1
    s_nop 1
    v_cndmask_b32 v8, v9, v8, vcc
    buffer_load_dwordx4 v[96:99], v8, s[16:19], 0 offen offset:0 sc1
    buffer_load_dwordx4 v[100:103], v8, s[16:19], 0 offen offset:512 sc1
    buffer_load_dwordx4 v[104:107], v8, s[16:19], 0 offen offset:1024 sc1
    buffer_load_dwordx4 v[108:111], v8, s[16:19], 0 offen offset:1536 sc1
    buffer_load_dwordx4 v[112:115], v8, s[16:19], 0 offen offset:2048 sc1
    buffer_load_dwordx4 v[116:119], v8, s[16:19], 0 offen offset:2560 sc1
    buffer_load_dwordx4 v[120:123], v8, s[16:19], 0 offen offset:3072 sc1
    buffer_load_dwordx4 v[124:127], v8, s[16:19], 0 offen offset:3584 sc1
    buffer_load_dwordx4 v[160:163], v47, s[12:15], s50 offen
    s_add_u32 s50, s50, 2048
    buffer_load_dwordx4 v[160:163], v47, s[12:15], s50 offen
    s_add_u32 s50, s50, 2048
    s_mov_b32 s38, 1
    s_mov_b32 s39, 0
    .p2align 6
L_sequential_preLN__sliding_local_dilated__glu_gated_geglu__prompt_kernel_l3_12:
    s_waitcnt vmcnt(12)
    s_barrier
    s_mul_i32 s46, s39, 16384
    s_add_u32 s46, s46, s45
    s_mul_i32 s47, s39, 28800
    s_add_u32 s47, s47, s44
    s_add_u32 m0, s46, 0
    s_nop 0
    buffer_load_dwordx4 v40, s[4:7], s43 offen sc1 lds
    s_add_u32 m0, s46, 1024
    s_nop 0
    buffer_load_dwordx4 v41, s[4:7], s43 offen sc1 lds
    s_add_u32 m0, s46, 2048
    s_nop 0
    buffer_load_dwordx4 v42, s[4:7], s43 offen sc1 lds
    s_add_u32 m0, s46, 3072
    s_nop 0
    buffer_load_dwordx4 v43, s[4:7], s43 offen sc1 lds
    s_add_u32 s43, s43, 128
    s_add_u32 m0, s47, 0
    s_nop 0
    buffer_load_dwordx4 v30, s[8:11], s41 offen lds
    s_add_u32 m0, s47, 1024
    s_nop 0
    buffer_load_dwordx4 v31, s[8:11], s41 offen lds
    s_add_u32 m0, s47, 2048
    s_nop 0
    buffer_load_dwordx4 v32, s[8:11], s41 offen lds
    s_add_u32 m0, s47, 3072
    s_nop 0
    buffer_load_dwordx4 v33, s[8:11], s41 offen lds
    s_add_u32 m0, s47, 4096
    s_nop 0
    buffer_load_dwordx4 v34, s[8:11], s41 offen lds
    s_add_u32 m0, s47, 5120
    s_nop 0
    buffer_load_dwordx4 v35, s[8:11], s41 offen lds
    s_add_u32 m0, s47, 6144
    s_nop 0
    buffer_load_dwordx4 v36, s[8:11], s41 offen lds
    s_add_u32 s41, s41, 229376
    buffer_load_dwordx4 v[160:163], v47, s[12:15], s50 offen
    s_add_u32 s50, s50, 2048
    s_add_u32 s39, s39, 1
    s_cmp_ge_u32 s39, 3
    s_cselect_b32 s39, 0, s39
    s_add_u32 s38, s38, 1
    s_cmp_lt_u32 s38, 6
    s_cbranch_scc1 L_sequential_preLN__sliding_local_dilated__glu_gated_geglu__prompt_kernel_l3_12
    s_waitcnt vmcnt(12)
    s_barrier
    v_add_f32 v64, v64, v66
    v_add_f32 v65, v65, v67
    v_add_f32 v68, v68, v70
    v_add_f32 v69, v69, v71
    v_add_f32_dpp v64, v64, v64 quad_perm:[1,0,3,2] row_mask:0xf bank_mask:0xf
    v_add_f32_dpp v65, v65, v65 quad_perm:[1,0,3,2] row_mask:0xf bank_mask:0xf
    v_add_f32_dpp v68, v68, v68 quad_perm:[1,0,3,2] row_mask:0xf bank_mask:0xf
    v_add_f32_dpp v69, v69, v69 quad_perm:[1,0,3,2] row_mask:0xf bank_mask:0xf
    v_add_f32_dpp v64, v64, v64 quad_perm:[2,3,0,1] row_mask:0xf bank_mask:0xf
    v_add_f32_dpp v65, v65, v65 quad_perm:[2,3,0,1] row_mask:0xf bank_mask:0xf
    v_add_f32_dpp v68, v68, v68 quad_perm:[2,3,0,1] row_mask:0xf bank_mask:0xf
    v_add_f32_dpp v69, v69, v69 quad_perm:[2,3,0,1] row_mask:0xf bank_mask:0xf
    v_lshrrev_b32 v6, 2, v1
    s_lshl_b32 s24, s21, 5
    v_add_u32 v6, s24, v6
    v_lshlrev_b32 v6, 3, v6
    v_add_u32 v6, 4096, v6
    v_mul_f32 v52, 989855744, v64
    v_mul_f32 v53, 989855744, v65
    v_fma_f32 v53, -v52, v52, v53
    v_max_f32 v53, 0, v53
    v_cvt_pk_bf16_f32 v54, v52, v52
    v_lshlrev_b32 v52, 16, v54
    v_cvt_pk_bf16_f32 v54, v53, v53
    v_lshlrev_b32 v53, 16, v54
    v_add_f32 v53, 925353388, v53
    v_cvt_pk_bf16_f32 v54, v53, v53
    v_lshlrev_b32 v53, 16, v54
    v_sqrt_f32 v53, v53
    s_nop 0
    v_cvt_pk_bf16_f32 v54, v53, v53
    v_lshlrev_b32 v53, 16, v54
    v_rcp_f32 v53, v53
    ds_write_b64 v6, v[52:53] offset:0
    v_mul_f32 v52, 989855744, v68
    v_mul_f32 v53, 989855744, v69
    v_fma_f32 v53, -v52, v52, v53
    v_max_f32 v53, 0, v53
    v_cvt_pk_bf16_f32 v54, v52, v52
    v_lshlrev_b32 v52, 16, v54
    v_cvt_pk_bf16_f32 v54, v53, v53
    v_lshlrev_b32 v53, 16, v54
    v_add_f32 v53, 925353388, v53
    v_cvt_pk_bf16_f32 v54, v53, v53
    v_lshlrev_b32 v53, 16, v54
    v_sqrt_f32 v53, v53
    s_nop 0
    v_cvt_pk_bf16_f32 v54, v53, v53
    v_lshlrev_b32 v53, 16, v54
    v_rcp_f32 v53, v53
    ds_write_b64 v6, v[52:53] offset:128
    v_add_f32 v96, v96, v100
    v_add_f32 v97, v97, v101
    v_add_f32 v98, v98, v102
    v_add_f32 v99, v99, v103
    v_add_f32 v96, v96, v104
    v_add_f32 v97, v97, v105
    v_add_f32 v98, v98, v106
    v_add_f32 v99, v99, v107
    v_add_f32 v96, v96, v108
    v_add_f32 v97, v97, v109
    v_add_f32 v98, v98, v110
    v_add_f32 v99, v99, v111
    v_add_f32 v96, v96, v112
    v_add_f32 v97, v97, v113
    v_add_f32 v98, v98, v114
    v_add_f32 v99, v99, v115
    v_add_f32 v96, v96, v116
    v_add_f32 v97, v97, v117
    v_add_f32 v98, v98, v118
    v_add_f32 v99, v99, v119
    v_add_f32 v96, v96, v120
    v_add_f32 v97, v97, v121
    v_add_f32 v98, v98, v122
    v_add_f32 v99, v99, v123
    v_add_f32 v96, v96, v124
    v_add_f32 v97, v97, v125
    v_add_f32 v98, v98, v126
    v_add_f32 v99, v99, v127
    v_min_u32 v8, 27, v1
    v_lshlrev_b32 v8, 3, v8
    s_and_b32 s46, s21, 1
    s_mul_i32 s46, s46, 14464
    s_add_u32 s46, s46, 40960
    v_add_u32 v8, s46, v8
    v_cmp_gt_u32 vcc, 28, v1
    s_nop 0
    s_and_saveexec_b64 s[60:61], vcc
    v_cvt_pk_bf16_f32 v100, v96, v97
    v_cvt_pk_bf16_f32 v101, v98, v99
    ds_write_b64 v8, v[100:101] offset:0
    v_lshlrev_b32 v102, 16, v100
    v_and_b32 v103, 0xffff0000, v100
    v_lshlrev_b32 v104, 16, v101
    v_and_b32 v105, 0xffff0000, v101
    v_sub_f32 v96, v96, v102
    v_sub_f32 v97, v97, v103
    v_sub_f32 v98, v98, v104
    v_sub_f32 v99, v99, v105
    v_cvt_pk_bf16_f32 v100, v96, v97
    v_cvt_pk_bf16_f32 v101, v98, v99
    ds_write_b64 v8, v[100:101] offset:224
    v_lshlrev_b32 v102, 16, v100
    v_and_b32 v103, 0xffff0000, v100
    v_lshlrev_b32 v104, 16, v101
    v_and_b32 v105, 0xffff0000, v101
    v_sub_f32 v96, v96, v102
    v_sub_f32 v97, v97, v103
    v_sub_f32 v98, v98, v104
    v_sub_f32 v99, v99, v105
    v_cvt_pk_bf16_f32 v100, v96, v97
    v_cvt_pk_bf16_f32 v101, v98, v99
    ds_write_b64 v8, v[100:101] offset:448
    s_mov_b64 exec, s[60:61]
    s_and_b32 s24, s21, 1
    s_mul_i32 s24, s24, 448
    v_add_u32 v5, s24, v1
    s_and_b32 s25, s76, 1
    s_lshl_b32 s25, s25, 11
    s_lshr_b32 s29, s76, 1
    s_mul_i32 s29, s29, 458752
    s_add_u32 s25, s25, s29
    s_lshl_b32 s26, s77, 7
    s_cmp_ge_u32 s21, 2
    s_cbranch_scc1 L_sequential_preLN__sliding_local_dilated__glu_gated_geglu__prompt_kernel_p4ws_13
    v_lshrrev_b32 v6, 7, v5
    v_bfe_u32 v7, v5, 1, 6
    v_bfe_u32 v8, v7, 3, 1
    v_and_b32 v9, 1, v5
    v_xor_b32 v8, v8, v9
    v_lshlrev_b32 v6, 12, v6
    v_lshl_add_u32 v6, v7, 5, v6
    v_lshl_add_u32 v6, v8, 4, v6
    v_add_u32 v24, s25, v6
    v_add_u32 v5, 64, v5
    v_lshrrev_b32 v6, 7, v5
    v_bfe_u32 v7, v5, 1, 6
    v_bfe_u32 v8, v7, 3, 1
    v_and_b32 v9, 1, v5
    v_xor_b32 v8, v8, v9
    v_lshlrev_b32 v6, 12, v6
    v_lshl_add_u32 v6, v7, 5, v6
    v_lshl_add_u32 v6, v8, 4, v6
    v_add_u32 v25, s25, v6
    v_add_u32 v5, 64, v5
    v_lshrrev_b32 v6, 7, v5
    v_bfe_u32 v7, v5, 1, 6
    v_bfe_u32 v8, v7, 3, 1
    v_and_b32 v9, 1, v5
    v_xor_b32 v8, v8, v9
    v_lshlrev_b32 v6, 12, v6
    v_lshl_add_u32 v6, v7, 5, v6
    v_lshl_add_u32 v6, v8, 4, v6
    v_add_u32 v26, s25, v6
    v_add_u32 v5, 64, v5
    v_lshrrev_b32 v6, 7, v5
    v_bfe_u32 v7, v5, 1, 6
    v_bfe_u32 v8, v7, 3, 1
    v_and_b32 v9, 1, v5
    v_xor_b32 v8, v8, v9
    v_lshlrev_b32 v6, 12, v6
    v_lshl_add_u32 v6, v7, 5, v6
    v_lshl_add_u32 v6, v8, 4, v6
    v_add_u32 v27, s25, v6
    v_add_u32 v5, 64, v5
    v_lshrrev_b32 v6, 7, v5
    v_bfe_u32 v7, v5, 1, 6
    v_bfe_u32 v8, v7, 3, 1
    v_and_b32 v9, 1, v5
    v_xor_b32 v8, v8, v9
    v_lshlrev_b32 v6, 12, v6
    v_lshl_add_u32 v6, v7, 5, v6
    v_lshl_add_u32 v6, v8, 4, v6
    v_add_u32 v28, s25, v6
    v_add_u32 v5, 64, v5
    v_lshrrev_b32 v6, 7, v5
    v_bfe_u32 v7, v5, 1, 6
    v_bfe_u32 v8, v7, 3, 1
    v_and_b32 v9, 1, v5
    v_xor_b32 v8, v8, v9
    v_lshlrev_b32 v6, 12, v6
    v_lshl_add_u32 v6, v7, 5, v6
    v_lshl_add_u32 v6, v8, 4, v6
    v_add_u32 v29, s25, v6
    v_add_u32 v5, 64, v5
    v_lshrrev_b32 v6, 7, v5
    v_bfe_u32 v7, v5, 1, 6
    v_bfe_u32 v8, v7, 3, 1
    v_and_b32 v9, 1, v5
    v_xor_b32 v8, v8, v9
    v_lshlrev_b32 v6, 12, v6
    v_lshl_add_u32 v6, v7, 5, v6
    v_lshl_add_u32 v6, v8, 4, v6
    v_add_u32 v30, s25, v6
    s_add_u32 s4, s82, 4194304
    s_addc_u32 s5, s83, 0
    s_mov_b32 s6, 7340032
    s_mov_b32 s7, 0x00020000
    s_mov_b32 s42, 28672
    s_mul_i32 s44, s21, 7168
    s_add_u32 s44, s44, 8192
    s_branch L_sequential_preLN__sliding_local_dilated__glu_gated_geglu__prompt_kernel_p4wd_14
L_sequential_preLN__sliding_local_dilated__glu_gated_geglu__prompt_kernel_p4ws_13:
    v_lshrrev_b32 v6, 3, v5
    v_and_b32 v7, 7, v5
    v_bfe_u32 v8, v6, 1, 1
    v_lshlrev_b32 v8, 2, v8
    v_xor_b32 v7, v7, v8
    v_lshlrev_b32 v6, 10, v6
    v_lshl_add_u32 v6, v7, 4, v6
    v_add_u32 v24, s26, v6
    v_add_u32 v25, 8192, v24
    v_add_u32 v26, 16384, v24
    v_add_u32 v27, 24576, v24
    v_add_u32 v28, 32768, v24
    v_add_u32 v29, 40960, v24
    v_add_u32 v30, 49152, v24
    s_mov_b32 s4, s96
    s_mov_b32 s5, s97
    s_mov_b32 s6, 1835008
    s_mov_b32 s7, 0x00020000
    s_mov_b32 s42, 114688
    s_and_b32 s44, s21, 1
    s_mul_i32 s44, s44, 7168
    s_add_u32 s44, s44, 81920
L_sequential_preLN__sliding_local_dilated__glu_gated_geglu__prompt_kernel_p4wd_14:
    s_mov_b32 s43, 0
    s_waitcnt vmcnt(1) lgkmcnt(0)
    s_barrier
    s_barrier
    s_setprio 0
    s_cmp_lt_u32 s21, 2
    s_cbranch_scc1 L_sequential_preLN__sliding_local_dilated__glu_gated_geglu__prompt_kernel_p4x_15
    s_mov_b32 s46, s44
    s_mov_b32 s38, 0
L_sequential_preLN__sliding_local_dilated__glu_gated_geglu__prompt_kernel_p4f_17:
    s_add_u32 m0, s46, 0
    s_nop 0
    buffer_load_dwordx4 v24, s[4:7], s43 offen sc1 lds
    s_add_u32 m0, s46, 1024
    s_nop 0
    buffer_load_dwordx4 v25, s[4:7], s43 offen sc1 lds
    s_add_u32 m0, s46, 2048
    s_nop 0
    buffer_load_dwordx4 v26, s[4:7], s43 offen sc1 lds
    s_add_u32 m0, s46, 3072
    s_nop 0
    buffer_load_dwordx4 v27, s[4:7], s43 offen sc1 lds
    s_add_u32 m0, s46, 4096
    s_nop 0
    buffer_load_dwordx4 v28, s[4:7], s43 offen sc1 lds
    s_add_u32 m0, s46, 5120
    s_nop 0
    buffer_load_dwordx4 v29, s[4:7], s43 offen sc1 lds
    s_add_u32 m0, s46, 6144
    s_nop 0
    buffer_load_dwordx4 v30, s[4:7], s43 offen sc1 lds
    s_add_u32 s43, s43, s42
    s_add_u32 s46, s46, 14336
    s_add_u32 s38, s38, 1
    s_cmp_lt_u32 s38, 5
    s_cbranch_scc1 L_sequential_preLN__sliding_local_dilated__glu_gated_geglu__prompt_kernel_p4f_17
    s_barrier
    s_setprio 3
    s_branch L_sequential_preLN__sliding_local_dilated__glu_gated_geglu__prompt_kernel_p4j_16
L_sequential_preLN__sliding_local_dilated__glu_gated_geglu__prompt_kernel_p4x_15:
    s_barrier
    s_setprio 3
    s_mov_b32 s46, s44
    s_mov_b32 s38, 0
L_sequential_preLN__sliding_local_dilated__glu_gated_geglu__prompt_kernel_p4f_18:
    s_add_u32 m0, s46, 0
    s_nop 0
    buffer_load_dwordx4 v24, s[4:7], s43 offen sc1 lds
    s_add_u32 m0, s46, 1024
    s_nop 0
    buffer_load_dwordx4 v25, s[4:7], s43 offen sc1 lds
    s_add_u32 m0, s46, 2048
    s_nop 0
    buffer_load_dwordx4 v26, s[4:7], s43 offen sc1 lds
    s_add_u32 m0, s46, 3072
    s_nop 0
    buffer_load_dwordx4 v27, s[4:7], s43 offen sc1 lds
    s_add_u32 m0, s46, 4096
    s_nop 0
    buffer_load_dwordx4 v28, s[4:7], s43 offen sc1 lds
    s_add_u32 m0, s46, 5120
    s_nop 0
    buffer_load_dwordx4 v29, s[4:7], s43 offen sc1 lds
    s_add_u32 m0, s46, 6144
    s_nop 0
    buffer_load_dwordx4 v30, s[4:7], s43 offen sc1 lds
    s_add_u32 s43, s43, s42
    s_add_u32 s46, s46, 14336
    s_add_u32 s38, s38, 1
    s_cmp_lt_u32 s38, 5
    s_cbranch_scc1 L_sequential_preLN__sliding_local_dilated__glu_gated_geglu__prompt_kernel_p4f_18
L_sequential_preLN__sliding_local_dilated__glu_gated_geglu__prompt_kernel_p4j_16:
    s_waitcnt vmcnt(28)
    s_barrier
    s_mov_b32 s38, 1
    s_mov_b32 s46, s44
    s_add_u32 s48, s44, 71680
    .p2align 6
L_sequential_preLN__sliding_local_dilated__glu_gated_geglu__prompt_kernel_l4_19:
    s_waitcnt vmcnt(21)
    s_barrier
    s_add_u32 m0, s46, 0
    s_nop 0
    buffer_load_dwordx4 v24, s[4:7], s43 offen sc1 lds
    s_add_u32 m0, s46, 1024
    s_nop 0
    buffer_load_dwordx4 v25, s[4:7], s43 offen sc1 lds
    s_add_u32 m0, s46, 2048
    s_nop 0
    buffer_load_dwordx4 v26, s[4:7], s43 offen sc1 lds
    s_add_u32 m0, s46, 3072
    s_nop 0
    buffer_load_dwordx4 v27, s[4:7], s43 offen sc1 lds
    s_add_u32 m0, s46, 4096
    s_nop 0
    buffer_load_dwordx4 v28, s[4:7], s43 offen sc1 lds
    s_add_u32 m0, s46, 5120
    s_nop 0
    buffer_load_dwordx4 v29, s[4:7], s43 offen sc1 lds
    s_add_u32 m0, s46, 6144
    s_nop 0
    buffer_load_dwordx4 v30, s[4:7], s43 offen sc1 lds
    s_add_u32 s43, s43, s42
    s_add_u32 s46, s46, 14336
    s_cmp_ge_u32 s46, s48
    s_cselect_b32 s46, s44, s46
    s_add_u32 s38, s38, 1
    s_cmp_lt_u32 s38, 12
    s_cbranch_scc1 L_sequential_preLN__sliding_local_dilated__glu_gated_geglu__prompt_kernel_l4_19
    s_waitcnt vmcnt(21)
    s_barrier
    s_waitcnt vmcnt(14)
    s_barrier
    s_waitcnt vmcnt(7)
    s_barrier
    s_waitcnt vmcnt(0)
    s_barrier
    s_barrier
    s_branch L_sequential_preLN__sliding_local_dilated__glu_gated_geglu__prompt_kernel_done_4
L_sequential_preLN__sliding_local_dilated__glu_gated_geglu__prompt_kernel_compute_3:
    s_mov_b32 s8, s84
    s_mov_b32 s9, s85
    s_mov_b32 s10, 2097152
    s_mov_b32 s11, 0x00020000
    s_add_u32 s12, s82, 14155776
    s_addc_u32 s13, s83, 0
    s_mov_b32 s14, 32768
    s_mov_b32 s15, 0x00020000
    s_lshl_b32 s62, s2, 3
    s_add_u32 s62, s62, s20
    s_lshl_b32 s29, s62, 10
    v_lshlrev_b32 v5, 4, v1
    v_mov_b32 v152, 0
    s_mov_b32 s4, s86
    s_mov_b32 s5, s87
    s_mov_b32 s6, 1572864
    s_mov_b32 s7, 0x00020000
    s_lshl_b32 s24, s62, 10
    buffer_load_dwordx4 v[160:163], v5, s[4:7], s24 offen
    buffer_load_dwordx4 v[148:151], v5, s[8:11], s29 offen
    s_and_b32 s27, s20, 3
    s_lshr_b32 s28, s20, 2
    v_and_b32 v3, 15, v1
    v_lshrrev_b32 v4, 4, v1
    v_lshrrev_b32 v5, 1, v3
    v_xor_b32 v5, v5, v4
    v_lshlrev_b32 v5, 4, v5
    v_lshlrev_b32 v6, 7, v3
    v_add_u32 v9, v5, v6
    v_lshrrev_b32 v5, 2, v3
    v_and_b32 v6, 3, v3
    v_lshlrev_b32 v7, 3, v4
    v_add_u32 v7, v5, v7
    v_mul_u32_u24 v7, 384, v7
    v_lshrrev_b32 v5, 1, v5
    v_and_b32 v8, 1, v4
    v_lshlrev_b32 v8, 1, v8
    v_or_b32 v5, v5, v8
    v_xor_b32 v5, s27, v5
    v_lshlrev_b32 v5, 5, v5
    v_add_u32 v7, v7, v5
    v_lshlrev_b32 v6, 3, v6
    v_add_u32 v7, v7, v6
    v_add_u32 v18, 10240, v7
    s_mov_b32 s55, 0x3f803f80
    s_mul_i32 s50, s28, 3
    s_add_u32 s51, s50, 1
    s_add_u32 s52, s50, 2
    v_mov_b32 v5, 144896
    v_lshl_add_u32 v5, v3, 2, v5
    v_mov_b32 v6, 0
    ds_write_b32 v5, v6
    s_lshl_b32 s24, s50, 11
    v_add_u32 v10, s24, v9
    v_xor_b32 v11, 64, v10
    s_lshl_b32 s24, s51, 11
    v_add_u32 v12, s24, v9
    v_xor_b32 v13, 64, v12
    s_lshl_b32 s24, s52, 11
    v_add_u32 v14, s24, v9
    v_xor_b32 v15, 64, v14
    v_mov_b32 v22, 0
    v_mov_b32 v23, 0
    v_mov_b32 v24, 0
    v_mov_b32 v25, 0
    v_mov_b32 v26, 0
    v_mov_b32 v27, 0
    v_mov_b32 v28, 0
    v_mov_b32 v29, 0
    v_mov_b32 v30, 0
    v_mov_b32 v64, 0
    v_mov_b32 v65, 0
    v_mov_b32 v66, 0
    v_mov_b32 v67, 0
    v_mov_b32 v68, 0
    v_mov_b32 v69, 0
    v_mov_b32 v70, 0
    v_mov_b32 v71, 0
    v_mov_b32 v72, 0
    v_mov_b32 v73, 0
    v_mov_b32 v74, 0
    v_mov_b32 v75, 0
    v_mov_b32 v76, 0
    v_mov_b32 v77, 0
    v_mov_b32 v78, 0
    v_mov_b32 v79, 0
    v_mov_b32 v80, 0
    v_mov_b32 v81, 0
    v_mov_b32 v82, 0
    v_mov_b32 v83, 0
    v_mov_b32 v84, 0
    v_mov_b32 v85, 0
    v_mov_b32 v86, 0
    v_mov_b32 v87, 0
    v_mov_b32 v88, 0
    v_mov_b32 v89, 0
    v_mov_b32 v90, 0
    v_mov_b32 v91, 0
    v_mov_b32 v92, 0
    v_mov_b32 v93, 0
    v_mov_b32 v94, 0
    v_mov_b32 v95, 0
    v_mov_b32 v96, 0
    v_mov_b32 v97, 0
    v_mov_b32 v98, 0
    v_mov_b32 v99, 0
    v_mov_b32 v124, 0
    v_mov_b32 v125, 0
    v_mov_b32 v126, 0
    v_mov_b32 v127, 0
    v_mov_b32 v128, 0
    v_mov_b32 v129, 0
    v_mov_b32 v130, 0
    v_mov_b32 v131, 0
    v_mov_b32 v132, 0
    v_mov_b32 v133, 0
    v_mov_b32 v134, 0
    v_mov_b32 v135, 0
    v_mov_b32 v136, 0
    v_mov_b32 v137, 0
    v_mov_b32 v138, 0
    v_mov_b32 v139, 0
    v_mov_b32 v140, 0
    v_mov_b32 v141, 0
    v_mov_b32 v142, 0
    v_mov_b32 v143, 0
    v_mov_b32 v144, 0
    v_mov_b32 v145, 0
    v_mov_b32 v146, 0
    v_mov_b32 v147, 0
    s_mov_b32 s16, s82
    s_mov_b32 s17, s83
    s_mov_b32 s18, 2097152
    s_mov_b32 s19, 0x00020000
    s_mov_b32 s49, 4294862848
    s_mov_b32 s56, 34816
    s_mov_b32 s38, 0
    s_mov_b32 s39, 0
    v_lshrrev_b32 v5, 3, v1
    v_and_b32 v5, 3, v5
    v_mul_u32_u24 v5, 34816, v5
    v_and_b32 v6, 7, v1
    v_lshlrev_b32 v6, 4, v6
    v_add_u32 v5, v5, v6
    v_mov_b32 v32, s55
    v_mov_b32 v33, s55
    v_mov_b32 v34, s55
    v_mov_b32 v35, s55
    ds_write_b128 v5, v[32:35]
    s_cmp_eq_u32 s28, 0
    s_cbranch_scc0 L_sequential_preLN__sliding_local_dilated__glu_gated_geglu__prompt_kernel_th1_20
    .p2align 6
L_sequential_preLN__sliding_local_dilated__glu_gated_geglu__prompt_kernel_loop_22:
    s_waitcnt lgkmcnt(0)
    s_barrier
    s_add_u32 s39, s39, 1
    s_cmp_ge_u32 s39, 4
    s_cselect_b32 s48, s49, s56
    s_cselect_b32 s39, 0, s39
    s_add_u32 s38, s38, 1
    v_mfma_f32_16x16x32_bf16 v[64:67], v[124:127], v[136:139], v[64:67]
    ds_read_b128 v[112:115], v10
    v_mfma_f32_16x16x32_bf16 v[68:71], v[128:131], v[136:139], v[68:71]
    ds_read_b64_tr_b16 v[100:101], v18 offset:0
    v_mfma_f32_16x16x32_bf16 v[72:75], v[132:135], v[136:139], v[72:75]
    ds_read_b64_tr_b16 v[102:103], v18 offset:1536
    ds_read_b64_tr_b16 v[104:105], v18 offset:128
    v_mfma_f32_16x16x32_bf16 v[76:79], v[124:127], v[140:143], v[76:79]
    v_mfma_f32_16x16x32_bf16 v[80:83], v[128:131], v[140:143], v[80:83]
    ds_read_b64_tr_b16 v[106:107], v18 offset:1664
    v_mfma_f32_16x16x32_bf16 v[84:87], v[132:135], v[140:143], v[84:87]
    ds_read_b64_tr_b16 v[108:109], v18 offset:256
    v_mfma_f32_16x16x32_bf16 v[88:91], v[124:127], v[144:147], v[88:91]
    ds_read_b64_tr_b16 v[110:111], v18 offset:1792
    v_mfma_f32_16x16x32_bf16 v[92:95], v[128:131], v[144:147], v[92:95]
    ds_read_b128 v[116:119], v12
    v_mfma_f32_16x16x32_bf16 v[96:99], v[132:135], v[144:147], v[96:99]
    ds_read_b128 v[120:123], v14
    s_waitcnt lgkmcnt(6)
    v_mfma_f32_16x16x32_bf16 v[64:67], v[100:103], v[112:115], v[64:67]
    ds_read_b128 v[136:139], v11
    s_waitcnt lgkmcnt(5)
    v_mfma_f32_16x16x32_bf16 v[68:71], v[104:107], v[112:115], v[68:71]
    ds_read_b64_tr_b16 v[124:125], v18 offset:12288
    s_waitcnt lgkmcnt(4)
    v_mfma_f32_16x16x32_bf16 v[72:75], v[108:111], v[112:115], v[72:75]
    ds_read_b64_tr_b16 v[126:127], v18 offset:13824
    ds_read_b64_tr_b16 v[128:129], v18 offset:12416
    s_waitcnt lgkmcnt(5)
    v_mfma_f32_16x16x32_bf16 v[76:79], v[100:103], v[116:119], v[76:79]
    v_mfma_f32_16x16x32_bf16 v[80:83], v[104:107], v[116:119], v[80:83]
    ds_read_b64_tr_b16 v[130:131], v18 offset:13952
    v_mfma_f32_16x16x32_bf16 v[84:87], v[108:111], v[116:119], v[84:87]
    ds_read_b64_tr_b16 v[132:133], v18 offset:12544
    s_waitcnt lgkmcnt(6)
    v_mfma_f32_16x16x32_bf16 v[88:91], v[100:103], v[120:123], v[88:91]
    ds_read_b64_tr_b16 v[134:135], v18 offset:14080
    v_mfma_f32_16x16x32_bf16 v[92:95], v[104:107], v[120:123], v[92:95]
    ds_read_b128 v[140:143], v13
    v_mfma_f32_16x16x32_bf16 v[96:99], v[108:111], v[120:123], v[96:99]
    ds_read_b128 v[144:147], v15
    v_add_u32 v10, s48, v10
    v_add_u32 v11, s48, v11
    v_add_u32 v12, s48, v12
    v_add_u32 v13, s48, v13
    v_add_u32 v14, s48, v14
    v_add_u32 v15, s48, v15
    v_add_u32 v18, s48, v18
    s_cmp_le_u32 s38, 3
    s_cbranch_scc1 L_sequential_preLN__sliding_local_dilated__glu_gated_geglu__prompt_kernel_xsn_26
L_sequential_preLN__sliding_local_dilated__glu_gated_geglu__prompt_kernel_xsb_24:
    s_cmp_lt_u32 s38, 8
    s_cbranch_scc1 L_sequential_preLN__sliding_local_dilated__glu_gated_geglu__prompt_kernel_loop_22
    s_branch L_sequential_preLN__sliding_local_dilated__glu_gated_geglu__prompt_kernel_xsd_25
L_sequential_preLN__sliding_local_dilated__glu_gated_geglu__prompt_kernel_xsn_26:
    s_cmp_eq_u32 s38, 3
    s_cbranch_scc1 L_sequential_preLN__sliding_local_dilated__glu_gated_geglu__prompt_kernel_xs2_23
    s_cmp_lg_u32 s20, 0
    s_cbranch_scc1 L_sequential_preLN__sliding_local_dilated__glu_gated_geglu__prompt_kernel_xsb_24
    s_cmp_eq_u32 s38, 2
    s_cbranch_scc1 L_sequential_preLN__sliding_local_dilated__glu_gated_geglu__prompt_kernel_xsn_26_2
    buffer_load_dword v153, v152, s[68:71], 0 offen sc1
    s_branch L_sequential_preLN__sliding_local_dilated__glu_gated_geglu__prompt_kernel_xsb_24
L_sequential_preLN__sliding_local_dilated__glu_gated_geglu__prompt_kernel_xsn_26_2:
    s_mov_b32 s59, 0
L_sequential_preLN__sliding_local_dilated__glu_gated_geglu__prompt_kernel_xsn_26_3:
    s_waitcnt vmcnt(0)
    v_readfirstlane_b32 s79, v153
    s_add_u32 s59, s59, 1
    s_cmp_lg_u32 s79, 0
    s_cbranch_scc1 L_sequential_preLN__sliding_local_dilated__glu_gated_geglu__prompt_kernel_xsn_26_4
    buffer_load_dword v153, v152, s[68:71], 0 offen sc1
    s_cmp_lt_u32 s59, 400000
    s_cbranch_scc1 L_sequential_preLN__sliding_local_dilated__glu_gated_geglu__prompt_kernel_xsn_26_3
L_sequential_preLN__sliding_local_dilated__glu_gated_geglu__prompt_kernel_xsn_26_4:
    v_mov_b32 v154, 139976
    ds_write_b32 v154, v153
    s_branch L_sequential_preLN__sliding_local_dilated__glu_gated_geglu__prompt_kernel_xsb_24
L_sequential_preLN__sliding_local_dilated__glu_gated_geglu__prompt_kernel_xs2_23:
    v_mov_b32 v154, 139976
    ds_read_b32 v153, v154
    v_mov_b32 v156, 0
    v_mov_b32 v157, 0
    s_waitcnt vmcnt(0)
    v_lshlrev_b32 v154, 16, v148
    v_and_b32 v155, 0xffff0000, v148
    v_add_f32 v156, v156, v154
    v_fmac_f32 v157, v154, v154
    v_add_f32 v156, v156, v155
    v_fmac_f32 v157, v155, v155
    v_lshlrev_b32 v154, 16, v149
    v_and_b32 v155, 0xffff0000, v149
    v_add_f32 v156, v156, v154
    v_fmac_f32 v157, v154, v154
    v_add_f32 v156, v156, v155
    v_fmac_f32 v157, v155, v155
    v_lshlrev_b32 v154, 16, v150
    v_and_b32 v155, 0xffff0000, v150
    v_add_f32 v156, v156, v154
    v_fmac_f32 v157, v154, v154
    v_add_f32 v156, v156, v155
    v_fmac_f32 v157, v155, v155
    v_lshlrev_b32 v154, 16, v151
    v_and_b32 v155, 0xffff0000, v151
    v_add_f32 v156, v156, v154
    v_fmac_f32 v157, v154, v154
    v_add_f32 v156, v156, v155
    v_fmac_f32 v157, v155, v155
    s_nop 0
    v_add_f32_dpp v156, v156, v156 quad_perm:[1,0,3,2] row_mask:0xf bank_mask:0xf
    v_add_f32_dpp v157, v157, v157 quad_perm:[1,0,3,2] row_mask:0xf bank_mask:0xf
    s_nop 0
    v_add_f32_dpp v156, v156, v156 quad_perm:[2,3,0,1] row_mask:0xf bank_mask:0xf
    v_add_f32_dpp v157, v157, v157 quad_perm:[2,3,0,1] row_mask:0xf bank_mask:0xf
    s_nop 0
    v_add_f32_dpp v156, v156, v156 row_half_mirror row_mask:0xf bank_mask:0xf
    v_add_f32_dpp v157, v157, v157 row_half_mirror row_mask:0xf bank_mask:0xf
    s_nop 0
    v_add_f32_dpp v156, v156, v156 row_mirror row_mask:0xf bank_mask:0xf
    v_add_f32_dpp v157, v157, v157 row_mirror row_mask:0xf bank_mask:0xf
    v_mov_b32 v154, v156
    s_nop 1
    v_permlane16_swap_b32 v156, v154
    v_add_f32 v156, v156, v154
    v_mov_b32 v154, v156
    s_nop 1
    v_permlane32_swap_b32 v156, v154
    v_add_f32 v156, v156, v154
    v_mov_b32 v154, v157
    s_nop 1
    v_permlane16_swap_b32 v157, v154
    v_add_f32 v157, v157, v154
    v_mov_b32 v154, v157
    s_nop 1
    v_permlane32_swap_b32 v157, v154
    v_add_f32 v157, v157, v154
    s_waitcnt lgkmcnt(0)
    v_readfirstlane_b32 s79, v153
    s_nop 1
    v_mov_b32 v158, s79
    v_mov_b32 v159, 0
    s_lshl_b32 s62, s62, 4
    v_mov_b32 v152, s62
    s_mov_b64 s[60:61], exec
    s_mov_b64 exec, 1
    buffer_store_dwordx4 v[156:159], v152, s[12:15], 0 offen sc1
    s_mov_b64 exec, s[60:61]
    s_lshl_b32 s62, s62, 6
    v_lshlrev_b32 v152, 4, v1
    s_branch L_sequential_preLN__sliding_local_dilated__glu_gated_geglu__prompt_kernel_xsb_24
L_sequential_preLN__sliding_local_dilated__glu_gated_geglu__prompt_kernel_xsd_25:
    s_waitcnt lgkmcnt(0)
    v_lshlrev_b32 v31, 3, v3
    v_add_u32 v31, 139264, v31
    v_mul_u32_u24 v40, 400, v3
    v_lshl_add_u32 v40, v4, 3, v40
    s_lshl_b32 s57, s27, 5
    v_add_u32 v40, s57, v40
    s_lshl_b32 s57, s50, 7
    v_add_u32 v33, s57, v31
    ds_read_b64 v[34:35], v33
    s_mul_i32 s57, s50, 6400
    v_add_u32 v42, s57, v40
    s_lshl_b32 s57, s51, 7
    v_add_u32 v33, s57, v31
    ds_read_b64 v[36:37], v33
    s_mul_i32 s57, s51, 6400
    v_add_u32 v43, s57, v40
    s_lshl_b32 s57, s52, 7
    v_add_u32 v33, s57, v31
    ds_read_b64 v[38:39], v33
    s_mul_i32 s57, s52, 6400
    v_add_u32 v44, s57, v40
    v_mfma_f32_16x16x32_bf16 v[64:67], v[124:127], v[136:139], v[64:67]
    v_mfma_f32_16x16x32_bf16 v[68:71], v[128:131], v[136:139], v[68:71]
    v_mfma_f32_16x16x32_bf16 v[72:75], v[132:135], v[136:139], v[72:75]
    v_mfma_f32_16x16x32_bf16 v[76:79], v[124:127], v[140:143], v[76:79]
    v_mfma_f32_16x16x32_bf16 v[80:83], v[128:131], v[140:143], v[80:83]
    v_mfma_f32_16x16x32_bf16 v[84:87], v[132:135], v[140:143], v[84:87]
    v_mfma_f32_16x16x32_bf16 v[88:91], v[124:127], v[144:147], v[88:91]
    v_mfma_f32_16x16x32_bf16 v[92:95], v[128:131], v[144:147], v[92:95]
    v_mfma_f32_16x16x32_bf16 v[96:99], v[132:135], v[144:147], v[96:99]
    s_lshl_b32 s57, s27, 6
    s_add_u32 s57, s57, 141824
    v_lshlrev_b32 v32, 4, v4
    v_add_u32 v32, s57, v32
    s_lshl_b32 s57, s27, 2
    s_add_u32 s57, s57, 144896
    v_mov_b32 v30, s57
    v_mov_b32_dpp v124, v64 row_newbcast:0 row_mask:0xf bank_mask:0xf
    v_mov_b32_dpp v125, v65 row_newbcast:0 row_mask:0xf bank_mask:0xf
    v_mov_b32_dpp v126, v66 row_newbcast:0 row_mask:0xf bank_mask:0xf
    v_mov_b32_dpp v127, v67 row_newbcast:0 row_mask:0xf bank_mask:0xf
    v_mov_b32_dpp v128, v68 row_newbcast:0 row_mask:0xf bank_mask:0xf
    v_mov_b32_dpp v129, v69 row_newbcast:0 row_mask:0xf bank_mask:0xf
    v_mov_b32_dpp v130, v70 row_newbcast:0 row_mask:0xf bank_mask:0xf
    v_mov_b32_dpp v131, v71 row_newbcast:0 row_mask:0xf bank_mask:0xf
    v_mov_b32_dpp v132, v72 row_newbcast:0 row_mask:0xf bank_mask:0xf
    v_mov_b32_dpp v133, v73 row_newbcast:0 row_mask:0xf bank_mask:0xf
    v_mov_b32_dpp v134, v74 row_newbcast:0 row_mask:0xf bank_mask:0xf
    v_mov_b32_dpp v135, v75 row_newbcast:0 row_mask:0xf bank_mask:0xf
    ds_write_b128 v32, v[124:127] offset:0
    ds_write_b128 v32, v[128:131] offset:256
    ds_write_b128 v32, v[132:135] offset:512
    v_mov_b32 v29, 1
    ds_write_b32 v30, v29
    s_waitcnt lgkmcnt(4)
    v_mul_f32 v76, v37, v76
    v_mul_f32 v77, v37, v77
    v_mul_f32 v78, v37, v78
    v_mul_f32 v79, v37, v79
    v_fmac_f32 v76, v36, v124
    v_fmac_f32 v77, v36, v125
    v_fmac_f32 v78, v36, v126
    v_fmac_f32 v79, v36, v127
    v_cvt_pk_bf16_f32 v76, v76, v77
    v_cvt_pk_bf16_f32 v77, v78, v79
    ds_write_b64 v43, v[76:77] offset:0
    v_mul_f32 v88, v39, v88
    v_mul_f32 v89, v39, v89
    v_mul_f32 v90, v39, v90
    v_mul_f32 v91, v39, v91
    v_fmac_f32 v88, v38, v124
    v_fmac_f32 v89, v38, v125
    v_fmac_f32 v90, v38, v126
    v_fmac_f32 v91, v38, v127
    v_cvt_pk_bf16_f32 v88, v88, v89
    v_cvt_pk_bf16_f32 v89, v90, v91
    ds_write_b64 v44, v[88:89] offset:0
    v_mul_f32 v68, v35, v68
    v_mul_f32 v69, v35, v69
    v_mul_f32 v70, v35, v70
    v_mul_f32 v71, v35, v71
    v_fmac_f32 v68, v34, v128
    v_fmac_f32 v69, v34, v129
    v_fmac_f32 v70, v34, v130
    v_fmac_f32 v71, v34, v131
    v_cvt_pk_bf16_f32 v68, v68, v69
    v_cvt_pk_bf16_f32 v69, v70, v71
    ds_write_b64 v42, v[68:69] offset:128
    v_mul_f32 v80, v37, v80
    v_mul_f32 v81, v37, v81
    v_mul_f32 v82, v37, v82
    v_mul_f32 v83, v37, v83
    v_fmac_f32 v80, v36, v128
    v_fmac_f32 v81, v36, v129
    v_fmac_f32 v82, v36, v130
    v_fmac_f32 v83, v36, v131
    v_cvt_pk_bf16_f32 v80, v80, v81
    v_cvt_pk_bf16_f32 v81, v82, v83
    ds_write_b64 v43, v[80:81] offset:128
    v_mul_f32 v92, v39, v92
    v_mul_f32 v93, v39, v93
    v_mul_f32 v94, v39, v94
    v_mul_f32 v95, v39, v95
    v_fmac_f32 v92, v38, v128
    v_fmac_f32 v93, v38, v129
    v_fmac_f32 v94, v38, v130
    v_fmac_f32 v95, v38, v131
    v_cvt_pk_bf16_f32 v92, v92, v93
    v_cvt_pk_bf16_f32 v93, v94, v95
    ds_write_b64 v44, v[92:93] offset:128
    v_mul_f32 v72, v35, v72
    v_mul_f32 v73, v35, v73
    v_mul_f32 v74, v35, v74
    v_mul_f32 v75, v35, v75
    v_fmac_f32 v72, v34, v132
    v_fmac_f32 v73, v34, v133
    v_fmac_f32 v74, v34, v134
    v_fmac_f32 v75, v34, v135
    v_cvt_pk_bf16_f32 v72, v72, v73
    v_cvt_pk_bf16_f32 v73, v74, v75
    ds_write_b64 v42, v[72:73] offset:256
    v_mul_f32 v84, v37, v84
    v_mul_f32 v85, v37, v85
    v_mul_f32 v86, v37, v86
    v_mul_f32 v87, v37, v87
    v_fmac_f32 v84, v36, v132
    v_fmac_f32 v85, v36, v133
    v_fmac_f32 v86, v36, v134
    v_fmac_f32 v87, v36, v135
    v_cvt_pk_bf16_f32 v84, v84, v85
    v_cvt_pk_bf16_f32 v85, v86, v87
    ds_write_b64 v43, v[84:85] offset:256
    v_mul_f32 v96, v39, v96
    v_mul_f32 v97, v39, v97
    v_mul_f32 v98, v39, v98
    v_mul_f32 v99, v39, v99
    v_fmac_f32 v96, v38, v132
    v_fmac_f32 v97, v38, v133
    v_fmac_f32 v98, v38, v134
    v_fmac_f32 v99, v38, v135
    v_cvt_pk_bf16_f32 v96, v96, v97
    v_cvt_pk_bf16_f32 v97, v98, v99
    ds_write_b64 v44, v[96:97] offset:256
    s_branch L_sequential_preLN__sliding_local_dilated__glu_gated_geglu__prompt_kernel_attn_21
L_sequential_preLN__sliding_local_dilated__glu_gated_geglu__prompt_kernel_th1_20:
    .p2align 6
L_sequential_preLN__sliding_local_dilated__glu_gated_geglu__prompt_kernel_loop_28:
    s_waitcnt lgkmcnt(0)
    s_barrier
    s_add_u32 s39, s39, 1
    s_cmp_ge_u32 s39, 4
    s_cselect_b32 s48, s49, s56
    s_cselect_b32 s39, 0, s39
    s_add_u32 s38, s38, 1
    v_mfma_f32_16x16x32_bf16 v[64:67], v[124:127], v[136:139], v[64:67]
    ds_read_b128 v[112:115], v10
    v_mfma_f32_16x16x32_bf16 v[68:71], v[128:131], v[136:139], v[68:71]
    ds_read_b64_tr_b16 v[100:101], v18 offset:0
    v_mfma_f32_16x16x32_bf16 v[72:75], v[132:135], v[136:139], v[72:75]
    ds_read_b64_tr_b16 v[102:103], v18 offset:1536
    ds_read_b64_tr_b16 v[104:105], v18 offset:128
    v_mfma_f32_16x16x32_bf16 v[76:79], v[124:127], v[140:143], v[76:79]
    ds_read_b64_tr_b16 v[106:107], v18 offset:1664
    v_mfma_f32_16x16x32_bf16 v[80:83], v[128:131], v[140:143], v[80:83]
    ds_read_b64_tr_b16 v[108:109], v18 offset:256
    v_mfma_f32_16x16x32_bf16 v[84:87], v[132:135], v[140:143], v[84:87]
    ds_read_b64_tr_b16 v[110:111], v18 offset:1792
    ds_read_b128 v[116:119], v12
    s_waitcnt lgkmcnt(5)
    v_mfma_f32_16x16x32_bf16 v[64:67], v[100:103], v[112:115], v[64:67]
    ds_read_b128 v[136:139], v11
    s_waitcnt lgkmcnt(4)
    v_mfma_f32_16x16x32_bf16 v[68:71], v[104:107], v[112:115], v[68:71]
    ds_read_b64_tr_b16 v[124:125], v18 offset:12288
    s_waitcnt lgkmcnt(3)
    v_mfma_f32_16x16x32_bf16 v[72:75], v[108:111], v[112:115], v[72:75]
    ds_read_b64_tr_b16 v[126:127], v18 offset:13824
    ds_read_b64_tr_b16 v[128:129], v18 offset:12416
    s_waitcnt lgkmcnt(4)
    v_mfma_f32_16x16x32_bf16 v[76:79], v[100:103], v[116:119], v[76:79]
    ds_read_b64_tr_b16 v[130:131], v18 offset:13952
    v_mfma_f32_16x16x32_bf16 v[80:83], v[104:107], v[116:119], v[80:83]
    ds_read_b64_tr_b16 v[132:133], v18 offset:12544
    v_mfma_f32_16x16x32_bf16 v[84:87], v[108:111], v[116:119], v[84:87]
    ds_read_b64_tr_b16 v[134:135], v18 offset:14080
    ds_read_b128 v[140:143], v13
    v_add_u32 v10, s48, v10
    v_add_u32 v11, s48, v11
    v_add_u32 v12, s48, v12
    v_add_u32 v13, s48, v13
    v_add_u32 v18, s48, v18
    s_cmp_le_u32 s38, 3
    s_cbranch_scc1 L_sequential_preLN__sliding_local_dilated__glu_gated_geglu__prompt_kernel_xsn_32
L_sequential_preLN__sliding_local_dilated__glu_gated_geglu__prompt_kernel_xsb_30:
    s_cmp_lt_u32 s38, 8
    s_cbranch_scc1 L_sequential_preLN__sliding_local_dilated__glu_gated_geglu__prompt_kernel_loop_28
    s_branch L_sequential_preLN__sliding_local_dilated__glu_gated_geglu__prompt_kernel_xsd_31
L_sequential_preLN__sliding_local_dilated__glu_gated_geglu__prompt_kernel_xsn_32:
    s_cmp_eq_u32 s38, 3
    s_cbranch_scc1 L_sequential_preLN__sliding_local_dilated__glu_gated_geglu__prompt_kernel_xs2_29
    s_cmp_lg_u32 s20, 0
    s_cbranch_scc1 L_sequential_preLN__sliding_local_dilated__glu_gated_geglu__prompt_kernel_xsb_30
    s_cmp_eq_u32 s38, 2
    s_cbranch_scc1 L_sequential_preLN__sliding_local_dilated__glu_gated_geglu__prompt_kernel_xsn_32_2
    buffer_load_dword v153, v152, s[68:71], 0 offen sc1
    s_branch L_sequential_preLN__sliding_local_dilated__glu_gated_geglu__prompt_kernel_xsb_30
L_sequential_preLN__sliding_local_dilated__glu_gated_geglu__prompt_kernel_xsn_32_2:
    s_mov_b32 s59, 0
L_sequential_preLN__sliding_local_dilated__glu_gated_geglu__prompt_kernel_xsn_32_3:
    s_waitcnt vmcnt(0)
    v_readfirstlane_b32 s79, v153
    s_add_u32 s59, s59, 1
    s_cmp_lg_u32 s79, 0
    s_cbranch_scc1 L_sequential_preLN__sliding_local_dilated__glu_gated_geglu__prompt_kernel_xsn_32_4
    buffer_load_dword v153, v152, s[68:71], 0 offen sc1
    s_cmp_lt_u32 s59, 400000
    s_cbranch_scc1 L_sequential_preLN__sliding_local_dilated__glu_gated_geglu__prompt_kernel_xsn_32_3
L_sequential_preLN__sliding_local_dilated__glu_gated_geglu__prompt_kernel_xsn_32_4:
    v_mov_b32 v154, 139976
    ds_write_b32 v154, v153
    s_branch L_sequential_preLN__sliding_local_dilated__glu_gated_geglu__prompt_kernel_xsb_30
L_sequential_preLN__sliding_local_dilated__glu_gated_geglu__prompt_kernel_xs2_29:
    v_mov_b32 v154, 139976
    ds_read_b32 v153, v154
    v_mov_b32 v156, 0
    v_mov_b32 v157, 0
    s_waitcnt vmcnt(0)
    v_lshlrev_b32 v154, 16, v148
    v_and_b32 v155, 0xffff0000, v148
    v_add_f32 v156, v156, v154
    v_fmac_f32 v157, v154, v154
    v_add_f32 v156, v156, v155
    v_fmac_f32 v157, v155, v155
    v_lshlrev_b32 v154, 16, v149
    v_and_b32 v155, 0xffff0000, v149
    v_add_f32 v156, v156, v154
    v_fmac_f32 v157, v154, v154
    v_add_f32 v156, v156, v155
    v_fmac_f32 v157, v155, v155
    v_lshlrev_b32 v154, 16, v150
    v_and_b32 v155, 0xffff0000, v150
    v_add_f32 v156, v156, v154
    v_fmac_f32 v157, v154, v154
    v_add_f32 v156, v156, v155
    v_fmac_f32 v157, v155, v155
    v_lshlrev_b32 v154, 16, v151
    v_and_b32 v155, 0xffff0000, v151
    v_add_f32 v156, v156, v154
    v_fmac_f32 v157, v154, v154
    v_add_f32 v156, v156, v155
    v_fmac_f32 v157, v155, v155
    s_nop 0
    v_add_f32_dpp v156, v156, v156 quad_perm:[1,0,3,2] row_mask:0xf bank_mask:0xf
    v_add_f32_dpp v157, v157, v157 quad_perm:[1,0,3,2] row_mask:0xf bank_mask:0xf
    s_nop 0
    v_add_f32_dpp v156, v156, v156 quad_perm:[2,3,0,1] row_mask:0xf bank_mask:0xf
    v_add_f32_dpp v157, v157, v157 quad_perm:[2,3,0,1] row_mask:0xf bank_mask:0xf
    s_nop 0
    v_add_f32_dpp v156, v156, v156 row_half_mirror row_mask:0xf bank_mask:0xf
    v_add_f32_dpp v157, v157, v157 row_half_mirror row_mask:0xf bank_mask:0xf
    s_nop 0
    v_add_f32_dpp v156, v156, v156 row_mirror row_mask:0xf bank_mask:0xf
    v_add_f32_dpp v157, v157, v157 row_mirror row_mask:0xf bank_mask:0xf
    v_mov_b32 v154, v156
    s_nop 1
    v_permlane16_swap_b32 v156, v154
    v_add_f32 v156, v156, v154
    v_mov_b32 v154, v156
    s_nop 1
    v_permlane32_swap_b32 v156, v154
    v_add_f32 v156, v156, v154
    v_mov_b32 v154, v157
    s_nop 1
    v_permlane16_swap_b32 v157, v154
    v_add_f32 v157, v157, v154
    v_mov_b32 v154, v157
    s_nop 1
    v_permlane32_swap_b32 v157, v154
    v_add_f32 v157, v157, v154
    s_waitcnt lgkmcnt(0)
    v_readfirstlane_b32 s79, v153
    s_nop 1
    v_mov_b32 v158, s79
    v_mov_b32 v159, 0
    s_lshl_b32 s62, s62, 4
    v_mov_b32 v152, s62
    s_mov_b64 s[60:61], exec
    s_mov_b64 exec, 1
    buffer_store_dwordx4 v[156:159], v152, s[12:15], 0 offen sc1
    s_mov_b64 exec, s[60:61]
    s_lshl_b32 s62, s62, 6
    v_lshlrev_b32 v152, 4, v1
    s_branch L_sequential_preLN__sliding_local_dilated__glu_gated_geglu__prompt_kernel_xsb_30
L_sequential_preLN__sliding_local_dilated__glu_gated_geglu__prompt_kernel_xsd_31:
    s_waitcnt lgkmcnt(0)
    v_lshlrev_b32 v31, 3, v3
    v_add_u32 v31, 139264, v31
    v_mul_u32_u24 v40, 400, v3
    v_lshl_add_u32 v40, v4, 3, v40
    s_lshl_b32 s57, s27, 5
    v_add_u32 v40, s57, v40
    s_lshl_b32 s57, s50, 7
    v_add_u32 v33, s57, v31
    ds_read_b64 v[34:35], v33
    s_mul_i32 s57, s50, 6400
    v_add_u32 v42, s57, v40
    s_lshl_b32 s57, s51, 7
    v_add_u32 v33, s57, v31
    ds_read_b64 v[36:37], v33
    s_mul_i32 s57, s51, 6400
    v_add_u32 v43, s57, v40
    v_mfma_f32_16x16x32_bf16 v[64:67], v[124:127], v[136:139], v[64:67]
    v_mfma_f32_16x16x32_bf16 v[68:71], v[128:131], v[136:139], v[68:71]
    v_mfma_f32_16x16x32_bf16 v[72:75], v[132:135], v[136:139], v[72:75]
    v_mfma_f32_16x16x32_bf16 v[76:79], v[124:127], v[140:143], v[76:79]
    v_mfma_f32_16x16x32_bf16 v[80:83], v[128:131], v[140:143], v[80:83]
    v_mfma_f32_16x16x32_bf16 v[84:87], v[132:135], v[140:143], v[84:87]
    s_lshl_b32 s57, s27, 6
    s_add_u32 s57, s57, 141824
    v_lshlrev_b32 v32, 4, v4
    v_add_u32 v32, s57, v32
    s_lshl_b32 s57, s27, 2
    s_add_u32 s57, s57, 144896
    v_mov_b32 v30, s57
L_sequential_preLN__sliding_local_dilated__glu_gated_geglu__prompt_kernel_csw_34:
    ds_read_b32 v29, v30
    s_waitcnt lgkmcnt(0)
    v_readfirstlane_b32 s57, v29
    s_nop 0
    s_cmp_eq_u32 s57, 0
    s_cbranch_scc1 L_sequential_preLN__sliding_local_dilated__glu_gated_geglu__prompt_kernel_csw_34
    ds_read_b128 v[124:127], v32 offset:0
    ds_read_b128 v[128:131], v32 offset:256
    ds_read_b128 v[132:135], v32 offset:512
    s_waitcnt lgkmcnt(0)
    v_mul_f32 v64, v35, v64
    v_mul_f32 v65, v35, v65
    v_mul_f32 v66, v35, v66
    v_mul_f32 v67, v35, v67
    v_fmac_f32 v64, v34, v124
    v_fmac_f32 v65, v34, v125
    v_fmac_f32 v66, v34, v126
    v_fmac_f32 v67, v34, v127
    v_cvt_pk_bf16_f32 v64, v64, v65
    v_cvt_pk_bf16_f32 v65, v66, v67
    ds_write_b64 v42, v[64:65] offset:0
    v_mul_f32 v76, v37, v76
    v_mul_f32 v77, v37, v77
    v_mul_f32 v78, v37, v78
    v_mul_f32 v79, v37, v79
    v_fmac_f32 v76, v36, v124
    v_fmac_f32 v77, v36, v125
    v_fmac_f32 v78, v36, v126
    v_fmac_f32 v79, v36, v127
    v_cvt_pk_bf16_f32 v76, v76, v77
    v_cvt_pk_bf16_f32 v77, v78, v79
    ds_write_b64 v43, v[76:77] offset:0
    v_mul_f32 v68, v35, v68
    v_mul_f32 v69, v35, v69
    v_mul_f32 v70, v35, v70
    v_mul_f32 v71, v35, v71
    v_fmac_f32 v68, v34, v128
    v_fmac_f32 v69, v34, v129
    v_fmac_f32 v70, v34, v130
    v_fmac_f32 v71, v34, v131
    v_cvt_pk_bf16_f32 v68, v68, v69
    v_cvt_pk_bf16_f32 v69, v70, v71
    ds_write_b64 v42, v[68:69] offset:128
    v_mul_f32 v80, v37, v80
    v_mul_f32 v81, v37, v81
    v_mul_f32 v82, v37, v82
    v_mul_f32 v83, v37, v83
    v_fmac_f32 v80, v36, v128
    v_fmac_f32 v81, v36, v129
    v_fmac_f32 v82, v36, v130
    v_fmac_f32 v83, v36, v131
    v_cvt_pk_bf16_f32 v80, v80, v81
    v_cvt_pk_bf16_f32 v81, v82, v83
    ds_write_b64 v43, v[80:81] offset:128
    v_mul_f32 v72, v35, v72
    v_mul_f32 v73, v35, v73
    v_mul_f32 v74, v35, v74
    v_mul_f32 v75, v35, v75
    v_fmac_f32 v72, v34, v132
    v_fmac_f32 v73, v34, v133
    v_fmac_f32 v74, v34, v134
    v_fmac_f32 v75, v34, v135
    v_cvt_pk_bf16_f32 v72, v72, v73
    v_cvt_pk_bf16_f32 v73, v74, v75
    ds_write_b64 v42, v[72:73] offset:256
    v_mul_f32 v84, v37, v84
    v_mul_f32 v85, v37, v85
    v_mul_f32 v86, v37, v86
    v_mul_f32 v87, v37, v87
    v_fmac_f32 v84, v36, v132
    v_fmac_f32 v85, v36, v133
    v_fmac_f32 v86, v36, v134
    v_fmac_f32 v87, v36, v135
    v_cvt_pk_bf16_f32 v84, v84, v85
    v_cvt_pk_bf16_f32 v85, v86, v87
    ds_write_b64 v43, v[84:85] offset:256
L_sequential_preLN__sliding_local_dilated__glu_gated_geglu__prompt_kernel_attn_21:
    v_mov_b32 v2, 32256
    v_mov_b32 v5, 0
    ds_write_b32 v2, v5
    s_waitcnt lgkmcnt(0)
    s_barrier
    v_lshrrev_b32 v2, 3, v0
    v_lshrrev_b32 v3, 1, v0
    v_and_b32 v3, 3, v3
    v_and_b32 v4, 1, v0
    v_add_u32 v5, 16, v2
    v_mul_u32_u24 v5, 400, v5
    v_lshlrev_b32 v6, 5, v3
    v_add_u32 v5, v5, v6
    v_mul_u32_u24 v6, 3200, v4
    v_sub_u32 v7, v5, v6
    v_subrev_u32 v7, 2400, v7
    v_lshlrev_b32 v8, 4, v4
    v_add_u32 v9, v7, v8
    v_xor_b32 v10, 1, v4
    v_mul_u32_u24 v10, 3200, v10
    v_sub_u32 v10, v5, v10
    v_subrev_u32 v10, 2400, v10
    v_add_u32 v10, v10, v8
    ds_read_b128 v[16:19], v5
    ds_read_b128 v[20:23], v5 offset:16
    ds_read_b128 v[24:27], v7 offset:2528
    ds_read_b128 v[28:31], v7 offset:2544
    ds_read_b128 v[32:35], v7 offset:1728
    ds_read_b128 v[36:39], v7 offset:1744
    ds_read_b128 v[40:43], v7 offset:928
    ds_read_b128 v[44:47], v7 offset:944
    ds_read_b128 v[48:51], v7 offset:128
    ds_read_b128 v[52:55], v7 offset:144
    ds_read_b128 v[64:67], v9 offset:2656
    ds_read_b128 v[68:71], v9 offset:1856
    ds_read_b128 v[72:75], v9 offset:1056
    ds_read_b128 v[76:79], v9 offset:256
    s_waitcnt lgkmcnt(4)
    ds_read_b128 v[80:83], v10 offset:2656
    ds_read_b128 v[84:87], v10 offset:1856
    ds_read_b128 v[88:91], v10 offset:1056
    ds_read_b128 v[92:95], v10 offset:256
    v_mov_b32 v96, 0
    v_mov_b32 v97, 0
    v_mov_b32 v98, 0
    v_mov_b32 v99, 0
    v_dot2_f32_bf16 v96, v16, v24, v96
    v_dot2_f32_bf16 v97, v16, v32, v97
    v_dot2_f32_bf16 v98, v16, v40, v98
    v_dot2_f32_bf16 v99, v16, v48, v99
    v_dot2_f32_bf16 v96, v17, v25, v96
    v_dot2_f32_bf16 v97, v17, v33, v97
    v_dot2_f32_bf16 v98, v17, v41, v98
    v_dot2_f32_bf16 v99, v17, v49, v99
    v_dot2_f32_bf16 v96, v18, v26, v96
    v_dot2_f32_bf16 v97, v18, v34, v97
    v_dot2_f32_bf16 v98, v18, v42, v98
    v_dot2_f32_bf16 v99, v18, v50, v99
    v_dot2_f32_bf16 v96, v19, v27, v96
    v_dot2_f32_bf16 v97, v19, v35, v97
    v_dot2_f32_bf16 v98, v19, v43, v98
    v_dot2_f32_bf16 v99, v19, v51, v99
    v_dot2_f32_bf16 v96, v20, v28, v96
    v_dot2_f32_bf16 v97, v20, v36, v97
    v_dot2_f32_bf16 v98, v20, v44, v98
    v_dot2_f32_bf16 v99, v20, v52, v99
    v_dot2_f32_bf16 v96, v21, v29, v96
    v_dot2_f32_bf16 v97, v21, v37, v97
    v_dot2_f32_bf16 v98, v21, v45, v98
    v_dot2_f32_bf16 v99, v21, v53, v99
    v_dot2_f32_bf16 v96, v22, v30, v96
    v_dot2_f32_bf16 v97, v22, v38, v97
    v_dot2_f32_bf16 v98, v22, v46, v98
    v_dot2_f32_bf16 v99, v22, v54, v99
    v_dot2_f32_bf16 v96, v23, v31, v96
    v_dot2_f32_bf16 v97, v23, v39, v97
    v_dot2_f32_bf16 v98, v23, v47, v98
    v_dot2_f32_bf16 v99, v23, v55, v99
    s_lshl_b32 s24, s76, 6
    v_add_u32 v11, s24, v2
    v_lshlrev_b32 v12, 3, v4
    v_sub_u32 v11, v11, v12
    s_mov_b32 s57, 3480120104
    v_mov_b32 v13, s57
    v_cvt_pk_bf16_f32 v100, v96, v97
    v_cvt_pk_bf16_f32 v101, v98, v99
    v_lshlrev_b32 v96, 16, v100
    v_and_b32 v97, 0xffff0000, v100
    v_lshlrev_b32 v98, 16, v101
    v_and_b32 v99, 0xffff0000, v101
    v_cmp_gt_i32 vcc, 0, v11
    s_nop 1
    v_cndmask_b32 v96, v96, v13, vcc
    v_cmp_gt_i32 vcc, 2, v11
    s_nop 1
    v_cndmask_b32 v97, v97, v13, vcc
    v_cmp_gt_i32 vcc, 4, v11
    s_nop 1
    v_cndmask_b32 v98, v98, v13, vcc
    v_cmp_gt_i32 vcc, 6, v11
    s_nop 1
    v_cndmask_b32 v99, v99, v13, vcc
    v_mov_b32_dpp v100, v96 quad_perm:[1,0,3,2] row_mask:0xf bank_mask:0xf
    v_mov_b32_dpp v101, v97 quad_perm:[1,0,3,2] row_mask:0xf bank_mask:0xf
    v_mov_b32_dpp v102, v98 quad_perm:[1,0,3,2] row_mask:0xf bank_mask:0xf
    v_mov_b32_dpp v103, v99 quad_perm:[1,0,3,2] row_mask:0xf bank_mask:0xf
    v_max3_f32 v12, v96, v97, v98
    v_max3_f32 v12, v12, v99, v100
    v_max3_f32 v12, v12, v101, v102
    v_max_f32 v12, v12, v103
    s_mov_b32 s57, 1052289595
    v_mul_f32 v12, s57, v12
    v_fma_f32 v96, v96, s57, -v12
    v_fma_f32 v97, v97, s57, -v12
    v_fma_f32 v98, v98, s57, -v12
    v_fma_f32 v99, v99, s57, -v12
    v_fma_f32 v100, v100, s57, -v12
    v_fma_f32 v101, v101, s57, -v12
    v_fma_f32 v102, v102, s57, -v12
    v_fma_f32 v103, v103, s57, -v12
    v_exp_f32 v96, v96
    v_exp_f32 v97, v97
    v_exp_f32 v98, v98
    v_exp_f32 v99, v99
    v_exp_f32 v100, v100
    v_exp_f32 v101, v101
    v_exp_f32 v102, v102
    v_exp_f32 v103, v103
    v_add_f32 v12, v96, v97
    v_add_f32 v13, v98, v99
    v_add_f32 v14, v100, v101
    v_add_f32 v15, v102, v103
    v_add_f32 v12, v12, v13
    v_add_f32 v14, v14, v15
    v_add_f32 v12, v12, v14
    v_rcp_f32 v12, v12
    s_nop 0
    v_mul_f32 v96, v96, v12
    v_mul_f32 v97, v97, v12
    v_mul_f32 v98, v98, v12
    v_mul_f32 v99, v99, v12
    v_mul_f32 v100, v100, v12
    v_mul_f32 v101, v101, v12
    v_mul_f32 v102, v102, v12
    v_mul_f32 v103, v103, v12
    v_cvt_pk_bf16_f32 v24, v96, 0
    v_lshlrev_b32 v32, 16, v24
    v_cvt_pk_bf16_f32 v25, v97, 0
    v_lshlrev_b32 v33, 16, v25
    v_cvt_pk_bf16_f32 v26, v98, 0
    v_lshlrev_b32 v34, 16, v26
    v_cvt_pk_bf16_f32 v27, v99, 0
    v_lshlrev_b32 v35, 16, v27
    v_cvt_pk_bf16_f32 v28, v100, 0
    v_lshlrev_b32 v36, 16, v28
    v_cvt_pk_bf16_f32 v29, v101, 0
    v_lshlrev_b32 v37, 16, v29
    v_cvt_pk_bf16_f32 v30, v102, 0
    v_lshlrev_b32 v38, 16, v30
    v_cvt_pk_bf16_f32 v31, v103, 0
    v_lshlrev_b32 v39, 16, v31
    v_mov_b32 v40, 0
    v_mov_b32 v41, 0
    v_mov_b32 v42, 0
    v_mov_b32 v43, 0
    v_mov_b32 v44, 0
    v_mov_b32 v45, 0
    v_mov_b32 v46, 0
    v_mov_b32 v47, 0
    s_waitcnt lgkmcnt(0)
    v_dot2_f32_bf16 v40, v64, v24, v40
    v_dot2_f32_bf16 v41, v64, v32, v41
    v_dot2_f32_bf16 v42, v65, v24, v42
    v_dot2_f32_bf16 v43, v65, v32, v43
    v_dot2_f32_bf16 v44, v66, v24, v44
    v_dot2_f32_bf16 v45, v66, v32, v45
    v_dot2_f32_bf16 v46, v67, v24, v46
    v_dot2_f32_bf16 v47, v67, v32, v47
    v_dot2_f32_bf16 v40, v68, v25, v40
    v_dot2_f32_bf16 v41, v68, v33, v41
    v_dot2_f32_bf16 v42, v69, v25, v42
    v_dot2_f32_bf16 v43, v69, v33, v43
    v_dot2_f32_bf16 v44, v70, v25, v44
    v_dot2_f32_bf16 v45, v70, v33, v45
    v_dot2_f32_bf16 v46, v71, v25, v46
    v_dot2_f32_bf16 v47, v71, v33, v47
    v_dot2_f32_bf16 v40, v72, v26, v40
    v_dot2_f32_bf16 v41, v72, v34, v41
    v_dot2_f32_bf16 v42, v73, v26, v42
    v_dot2_f32_bf16 v43, v73, v34, v43
    v_dot2_f32_bf16 v44, v74, v26, v44
    v_dot2_f32_bf16 v45, v74, v34, v45
    v_dot2_f32_bf16 v46, v75, v26, v46
    v_dot2_f32_bf16 v47, v75, v34, v47
    v_dot2_f32_bf16 v40, v76, v27, v40
    v_dot2_f32_bf16 v41, v76, v35, v41
    v_dot2_f32_bf16 v42, v77, v27, v42
    v_dot2_f32_bf16 v43, v77, v35, v43
    v_dot2_f32_bf16 v44, v78, v27, v44
    v_dot2_f32_bf16 v45, v78, v35, v45
    v_dot2_f32_bf16 v46, v79, v27, v46
    v_dot2_f32_bf16 v47, v79, v35, v47
    v_dot2_f32_bf16 v40, v80, v28, v40
    v_dot2_f32_bf16 v41, v80, v36, v41
    v_dot2_f32_bf16 v42, v81, v28, v42
    v_dot2_f32_bf16 v43, v81, v36, v43
    v_dot2_f32_bf16 v44, v82, v28, v44
    v_dot2_f32_bf16 v45, v82, v36, v45
    v_dot2_f32_bf16 v46, v83, v28, v46
    v_dot2_f32_bf16 v47, v83, v36, v47
    v_dot2_f32_bf16 v40, v84, v29, v40
    v_dot2_f32_bf16 v41, v84, v37, v41
    v_dot2_f32_bf16 v42, v85, v29, v42
    v_dot2_f32_bf16 v43, v85, v37, v43
    v_dot2_f32_bf16 v44, v86, v29, v44
    v_dot2_f32_bf16 v45, v86, v37, v45
    v_dot2_f32_bf16 v46, v87, v29, v46
    v_dot2_f32_bf16 v47, v87, v37, v47
    v_dot2_f32_bf16 v40, v88, v30, v40
    v_dot2_f32_bf16 v41, v88, v38, v41
    v_dot2_f32_bf16 v42, v89, v30, v42
    v_dot2_f32_bf16 v43, v89, v38, v43
    v_dot2_f32_bf16 v44, v90, v30, v44
    v_dot2_f32_bf16 v45, v90, v38, v45
    v_dot2_f32_bf16 v46, v91, v30, v46
    v_dot2_f32_bf16 v47, v91, v38, v47
    v_dot2_f32_bf16 v40, v92, v31, v40
    v_dot2_f32_bf16 v41, v92, v39, v41
    v_dot2_f32_bf16 v42, v93, v31, v42
    v_dot2_f32_bf16 v43, v93, v39, v43
    v_dot2_f32_bf16 v44, v94, v31, v44
    v_dot2_f32_bf16 v45, v94, v39, v45
    v_dot2_f32_bf16 v46, v95, v31, v46
    v_dot2_f32_bf16 v47, v95, v39, v47
    v_cvt_pk_bf16_f32 v48, v40, v41
    v_cvt_pk_bf16_f32 v49, v42, v43
    v_cvt_pk_bf16_f32 v50, v44, v45
    v_cvt_pk_bf16_f32 v51, v46, v47
    v_add_u32 v11, s24, v2
    v_lshlrev_b32 v11, 10, v11
    v_and_b32 v12, 7, v0
    v_lshlrev_b32 v12, 4, v12
    v_add_u32 v11, v11, v12
    s_lshl_b32 s26, s77, 7
    v_add_u32 v11, s26, v11
    buffer_store_dwordx4 v[48:51], v11, s[16:19], 0 offen sc1
    v_mov_b32 v2, 32256
    v_mov_b32 v5, 1
    s_lshl_b32 s59, s76, 7
    s_lshl_b32 s58, s77, 2
    s_add_u32 s59, s59, s58
    s_lshl_b32 s59, s59, 5
    v_mov_b32 v6, s59
    v_mov_b32 v7, s79
    s_lshl_b32 s58, s76, 7
    v_and_b32 v8, 7, v1
    v_lshlrev_b32 v8, 7, v8
    s_lshl_b32 s58, s58, 5
    v_add_u32 v8, s58, v8
    s_waitcnt vmcnt(0)
    s_mov_b64 s[60:61], exec
    s_mov_b64 exec, 1
    ds_add_rtn_u32 v5, v2, v5
    s_waitcnt lgkmcnt(0)
    v_readfirstlane_b32 s59, v5
    s_nop 0
    s_cmp_lg_u32 s59, 7
    s_cbranch_scc1 L_sequential_preLN__sliding_local_dilated__glu_gated_geglu__prompt_kernel_nopub_36
    buffer_store_dword v7, v6, s[64:67], 0 offen sc1
L_sequential_preLN__sliding_local_dilated__glu_gated_geglu__prompt_kernel_nopub_36:
    s_mov_b64 exec, s[60:61]
    s_cmp_lg_u32 s20, 0
    s_cbranch_scc1 L_sequential_preLN__sliding_local_dilated__glu_gated_geglu__prompt_kernel_sync_35
    s_mov_b32 s59, 0
    buffer_load_dword v55, v8, s[64:67], 0 offen sc1
L_sequential_preLN__sliding_local_dilated__glu_gated_geglu__prompt_kernel_poll_37:
    s_sleep 2
    buffer_load_dword v56, v8, s[64:67], 0 offen sc1
    s_waitcnt vmcnt(1)
    v_cmp_ne_u32 vcc, s79, v55
    s_nop 0
    s_cmp_eq_u64 vcc, 0
    s_cbranch_scc1 L_sequential_preLN__sliding_local_dilated__glu_gated_geglu__prompt_kernel_polld_38
    s_sleep 2
    buffer_load_dword v55, v8, s[64:67], 0 offen sc1
    s_waitcnt vmcnt(1)
    v_cmp_ne_u32 vcc, s79, v56
    s_add_u32 s59, s59, 1
    s_cmp_eq_u64 vcc, 0
    s_cbranch_scc1 L_sequential_preLN__sliding_local_dilated__glu_gated_geglu__prompt_kernel_polld_38
    s_cmp_lt_u32 s59, 200000
    s_cbranch_scc1 L_sequential_preLN__sliding_local_dilated__glu_gated_geglu__prompt_kernel_poll_37
L_sequential_preLN__sliding_local_dilated__glu_gated_geglu__prompt_kernel_polld_38:
L_sequential_preLN__sliding_local_dilated__glu_gated_geglu__prompt_kernel_sync_35:
    s_barrier
    s_and_b32 s27, s20, 1
    s_lshr_b32 s28, s20, 1
    s_and_b32 s28, s28, 1
    s_lshr_b32 s29, s20, 2
    v_and_b32 v3, 31, v1
    s_lshl_b32 s24, s27, 5
    v_add_u32 v3, s24, v3
    v_lshrrev_b32 v4, 5, v1
    v_lshrrev_b32 v5, 4, v1
    v_and_b32 v6, 1, v5
    v_lshrrev_b32 v5, 1, v5
    v_and_b32 v7, 15, v1
    v_lshrrev_b32 v8, 2, v7
    v_and_b32 v7, 3, v7
    v_lshl_add_u32 v5, v5, 3, v8
    v_lshlrev_b32 v5, 7, v5
    v_lshrrev_b32 v8, 1, v8
    v_xor_b32 v8, s28, v8
    v_lshl_add_u32 v5, v8, 6, v5
    v_lshl_add_u32 v5, v6, 5, v5
    v_lshl_add_u32 v9, v7, 3, v5
    v_mov_b32 v32, 0
    v_mov_b32 v33, 0
    v_mov_b32 v34, 0
    v_mov_b32 v35, 0
    v_mov_b32 v36, 0
    v_mov_b32 v37, 0
    v_mov_b32 v38, 0
    v_mov_b32 v39, 0
    v_mov_b32 v40, 0
    v_mov_b32 v41, 0
    v_mov_b32 v42, 0
    v_mov_b32 v43, 0
    v_mov_b32 v44, 0
    v_mov_b32 v45, 0
    v_mov_b32 v46, 0
    v_mov_b32 v47, 0
    v_mov_b32 v96, 0
    v_mov_b32 v97, 0
    v_mov_b32 v98, 0
    v_mov_b32 v99, 0
    v_mov_b32 v100, 0
    v_mov_b32 v101, 0
    v_mov_b32 v102, 0
    v_mov_b32 v103, 0
    v_mov_b32 v104, 0
    v_mov_b32 v105, 0
    v_mov_b32 v106, 0
    v_mov_b32 v107, 0
    v_mov_b32 v108, 0
    v_mov_b32 v109, 0
    v_mov_b32 v110, 0
    v_mov_b32 v111, 0
    v_and_b32 v5, 15, v3
    v_xor_b32 v5, v5, v4
    v_lshlrev_b32 v5, 4, v5
    v_lshl_add_u32 v5, v3, 8, v5
    s_lshl_b32 s24, s29, 7
    v_xor_b32 v5, s24, v5
    v_add_u32 v10, 98304, v5
    v_xor_b32 v11, 32, v10
    v_xor_b32 v12, 64, v10
    v_xor_b32 v13, 0x60, v10
    s_lshl_b32 s24, s29, 13
    s_add_u32 s24, s24, 32768
    v_add_u32 v14, s24, v9
    v_lshrrev_b32 v5, 3, v0
    s_lshl_b32 s25, s76, 6
    v_add_u32 v5, s25, v5
    v_and_b32 v6, 7, v0
    v_lshlrev_b32 v6, 4, v6
    v_lshl_add_u32 v5, v5, 10, v6
    s_lshl_b32 s26, s77, 7
    v_add_u32 v57, s26, v5
    s_mov_b32 s12, s84
    s_mov_b32 s13, s85
    s_mov_b32 s14, 2097152
    s_mov_b32 s15, 0x00020000
    buffer_load_dwordx4 v[58:61], v57, s[12:15], 0 offen
    s_add_u32 s16, s82, 2097152
    s_addc_u32 s17, s83, 0
    s_mov_b32 s18, 2097152
    s_mov_b32 s19, 0x00020000
    v_mul_u32_u24 v5, 272, v3
    v_lshl_add_u32 v5, v4, 4, v5
    s_mul_i32 s24, s29, 17408
    s_lshl_b32 s30, s28, 7
    s_add_u32 s24, s24, s30
    s_add_u32 s24, s24, 0
    v_add_u32 v16, s24, v5
    v_lshrrev_b32 v6, 3, v0
    v_mul_u32_u24 v5, 272, v6
    v_and_b32 v7, 7, v0
    v_lshl_add_u32 v5, v7, 5, v5
    v_add_u32 v17, 0, v5
    s_lshl_b32 s24, s76, 6
    v_add_u32 v6, s24, v6
    v_lshlrev_b32 v6, 6, v6
    s_lshl_b32 s24, s77, 3
    v_add_u32 v6, s24, v6
    v_mov_b32 v5, 0x80000000
    v_cmp_eq_u32 vcc, 0, v7
    s_nop 1
    v_cndmask_b32 v18, v5, v6, vcc
    s_waitcnt lgkmcnt(0)
    s_barrier
    ds_read_b128 v[80:83], v10 offset:0
    ds_read_b64_tr_b16 v[84:85], v14 offset:0
    ds_read_b64_tr_b16 v[86:87], v14 offset:512
    ds_read_b128 v[88:91], v11 offset:0
    ds_read_b64_tr_b16 v[92:93], v14 offset:2048
    ds_read_b64_tr_b16 v[94:95], v14 offset:2560
    ds_read_b128 v[96:99], v12 offset:0
    ds_read_b64_tr_b16 v[100:101], v14 offset:4096
    ds_read_b64_tr_b16 v[102:103], v14 offset:4608
    ds_read_b128 v[104:107], v13 offset:0
    ds_read_b64_tr_b16 v[108:109], v14 offset:6144
    ds_read_b64_tr_b16 v[110:111], v14 offset:6656
    s_waitcnt lgkmcnt(6)
    v_mfma_f32_32x32x16_bf16 v[32:47], v[84:87], v[80:83], v[32:47]
    v_mfma_f32_32x32x16_bf16 v[32:47], v[92:95], v[88:91], v[32:47]
    s_waitcnt lgkmcnt(0)
    s_barrier
    ds_read_b128 v[80:83], v10 offset:16384
    ds_read_b64_tr_b16 v[84:85], v14 offset:16384
    ds_read_b64_tr_b16 v[86:87], v14 offset:16896
    ds_read_b128 v[88:91], v11 offset:16384
    ds_read_b64_tr_b16 v[92:93], v14 offset:18432
    ds_read_b64_tr_b16 v[94:95], v14 offset:18944
    v_mfma_f32_32x32x16_bf16 v[32:47], v[100:103], v[96:99], v[32:47]
    v_mfma_f32_32x32x16_bf16 v[32:47], v[108:111], v[104:107], v[32:47]
    ds_read_b128 v[96:99], v12 offset:16384
    ds_read_b64_tr_b16 v[100:101], v14 offset:20480
    ds_read_b64_tr_b16 v[102:103], v14 offset:20992
    ds_read_b128 v[104:107], v13 offset:16384
    ds_read_b64_tr_b16 v[108:109], v14 offset:22528
    ds_read_b64_tr_b16 v[110:111], v14 offset:23040
    s_waitcnt lgkmcnt(6)
    v_mfma_f32_32x32x16_bf16 v[32:47], v[84:87], v[80:83], v[32:47]
    v_mfma_f32_32x32x16_bf16 v[32:47], v[92:95], v[88:91], v[32:47]
    s_waitcnt lgkmcnt(0)
    s_barrier
    ds_read_b128 v[80:83], v10 offset:32768
    ds_read_b64_tr_b16 v[84:85], v14 offset:32768
    ds_read_b64_tr_b16 v[86:87], v14 offset:33280
    ds_read_b128 v[88:91], v11 offset:32768
    ds_read_b64_tr_b16 v[92:93], v14 offset:34816
    ds_read_b64_tr_b16 v[94:95], v14 offset:35328
    v_mfma_f32_32x32x16_bf16 v[32:47], v[100:103], v[96:99], v[32:47]
    v_mfma_f32_32x32x16_bf16 v[32:47], v[108:111], v[104:107], v[32:47]
    ds_read_b128 v[96:99], v12 offset:32768
    ds_read_b64_tr_b16 v[100:101], v14 offset:36864
    ds_read_b64_tr_b16 v[102:103], v14 offset:37376
    ds_read_b128 v[104:107], v13 offset:32768
    ds_read_b64_tr_b16 v[108:109], v14 offset:38912
    ds_read_b64_tr_b16 v[110:111], v14 offset:39424
    s_waitcnt lgkmcnt(6)
    v_mfma_f32_32x32x16_bf16 v[32:47], v[84:87], v[80:83], v[32:47]
    v_mfma_f32_32x32x16_bf16 v[32:47], v[92:95], v[88:91], v[32:47]
    s_waitcnt lgkmcnt(0)
    s_barrier
    ds_read_b128 v[80:83], v10 offset:49152
    ds_read_b64_tr_b16 v[84:85], v14 offset:49152
    ds_read_b64_tr_b16 v[86:87], v14 offset:49664
    ds_read_b128 v[88:91], v11 offset:49152
    ds_read_b64_tr_b16 v[92:93], v14 offset:51200
    ds_read_b64_tr_b16 v[94:95], v14 offset:51712
    v_mfma_f32_32x32x16_bf16 v[32:47], v[100:103], v[96:99], v[32:47]
    v_mfma_f32_32x32x16_bf16 v[32:47], v[108:111], v[104:107], v[32:47]
    ds_read_b128 v[96:99], v12 offset:49152
    ds_read_b64_tr_b16 v[100:101], v14 offset:53248
    ds_read_b64_tr_b16 v[102:103], v14 offset:53760
    ds_read_b128 v[104:107], v13 offset:49152
    ds_read_b64_tr_b16 v[108:109], v14 offset:55296
    ds_read_b64_tr_b16 v[110:111], v14 offset:55808
    s_waitcnt lgkmcnt(6)
    v_mfma_f32_32x32x16_bf16 v[32:47], v[84:87], v[80:83], v[32:47]
    v_mfma_f32_32x32x16_bf16 v[32:47], v[92:95], v[88:91], v[32:47]
    s_waitcnt lgkmcnt(0)
    v_mfma_f32_32x32x16_bf16 v[32:47], v[100:103], v[96:99], v[32:47]
    v_mfma_f32_32x32x16_bf16 v[32:47], v[108:111], v[104:107], v[32:47]
    s_nop 11
    ds_write_b128 v16, v[32:35] offset:0
    ds_write_b128 v16, v[36:39] offset:32
    ds_write_b128 v16, v[40:43] offset:64
    ds_write_b128 v16, v[44:47] offset:96
    v_mov_b32 v2, 40960
    v_mov_b32 v5, 0
    ds_write_b32 v2, v5
    s_add_u32 s12, s82, 14417920
    s_addc_u32 s13, s83, 0
    s_mov_b32 s14, 131072
    s_mov_b32 s15, 0x00020000
    s_waitcnt vmcnt(0)
    v_lshlrev_b32 v64, 16, v58
    v_and_b32 v65, 0xffff0000, v58
    v_lshlrev_b32 v66, 16, v59
    v_and_b32 v67, 0xffff0000, v59
    v_lshlrev_b32 v68, 16, v60
    v_and_b32 v69, 0xffff0000, v60
    v_lshlrev_b32 v70, 16, v61
    v_and_b32 v71, 0xffff0000, v61
    s_waitcnt lgkmcnt(0)
    s_barrier
    ds_read_b128 v[32:35], v17
    ds_read_b128 v[40:43], v17 offset:17408
    ds_read_b128 v[36:39], v17 offset:16
    ds_read_b128 v[44:47], v17 offset:17424
    s_waitcnt lgkmcnt(2)
    v_add_f32 v32, v32, v40
    v_add_f32 v33, v33, v41
    v_add_f32 v34, v34, v42
    v_add_f32 v35, v35, v43
    v_add_f32 v32, v32, v64
    v_add_f32 v33, v33, v65
    v_add_f32 v34, v34, v66
    v_add_f32 v35, v35, v67
    s_waitcnt lgkmcnt(0)
    v_add_f32 v36, v36, v44
    v_add_f32 v37, v37, v45
    v_add_f32 v38, v38, v46
    v_add_f32 v39, v39, v47
    v_add_f32 v36, v36, v68
    v_add_f32 v37, v37, v69
    v_add_f32 v38, v38, v70
    v_add_f32 v39, v39, v71
    v_cvt_pk_bf16_f32 v58, v32, v33
    v_cvt_pk_bf16_f32 v59, v34, v35
    v_cvt_pk_bf16_f32 v60, v36, v37
    v_cvt_pk_bf16_f32 v61, v38, v39
    buffer_store_dwordx4 v[58:61], v57, s[16:19], 0 offen sc1
    v_add_f32 v44, v32, v33
    v_mul_f32 v45, v32, v32
    v_add_f32 v46, v34, v35
    v_mul_f32 v47, v33, v33
    v_add_f32 v44, v44, v36
    v_fmac_f32 v45, v34, v34
    v_add_f32 v46, v46, v37
    v_fmac_f32 v47, v35, v35
    v_add_f32 v44, v44, v38
    v_fmac_f32 v45, v36, v36
    v_add_f32 v46, v46, v39
    v_fmac_f32 v47, v37, v37
    v_add_f32 v44, v44, v46
    v_fmac_f32 v45, v38, v38
    v_fmac_f32 v47, v39, v39
    v_add_f32 v45, v45, v47
    v_add_f32_dpp v44, v44, v44 quad_perm:[1,0,3,2] row_mask:0xf bank_mask:0xf
    s_nop 0
    v_add_f32_dpp v45, v45, v45 quad_perm:[1,0,3,2] row_mask:0xf bank_mask:0xf
    v_add_f32_dpp v44, v44, v44 quad_perm:[2,3,0,1] row_mask:0xf bank_mask:0xf
    s_nop 0
    v_add_f32_dpp v45, v45, v45 quad_perm:[2,3,0,1] row_mask:0xf bank_mask:0xf
    v_add_f32_dpp v44, v44, v44 row_half_mirror row_mask:0xf bank_mask:0xf
    s_nop 0
    v_add_f32_dpp v45, v45, v45 row_half_mirror row_mask:0xf bank_mask:0xf
    buffer_store_dwordx2 v[44:45], v18, s[12:15], 0 offen sc1
    v_mov_b32 v2, 40960
    v_mov_b32 v5, 1
    s_lshr_b32 s59, s76, 1
    s_lshl_b32 s59, s59, 7
    s_add_u32 s59, s59, 8192
    s_and_b32 s58, s76, 1
    s_lshl_b32 s58, s58, 3
    s_add_u32 s58, s58, s77
    s_lshl_b32 s58, s58, 2
    s_add_u32 s59, s59, s58
    s_lshl_b32 s59, s59, 5
    v_mov_b32 v6, s59
    v_mov_b32 v7, s79
    s_lshl_b32 s58, s74, 7
    s_add_u32 s58, s58, 8192
    v_and_b32 v8, 15, v1
    v_lshlrev_b32 v8, 7, v8
    s_lshl_b32 s58, s58, 5
    v_add_u32 v8, s58, v8
    s_lshl_b32 s58, s75, 7
    s_add_u32 s58, s58, 24576
    v_and_b32 v9, 15, v1
    v_lshlrev_b32 v9, 7, v9
    s_lshl_b32 s58, s58, 5
    v_add_u32 v9, s58, v9
    v_cmp_gt_u32 vcc, 32, v1
    s_nop 1
    v_cndmask_b32 v8, v9, v8, vcc
    s_waitcnt vmcnt(0)
    s_mov_b64 s[60:61], exec
    s_mov_b64 exec, 1
    ds_add_rtn_u32 v5, v2, v5
    s_waitcnt lgkmcnt(0)
    v_readfirstlane_b32 s59, v5
    s_nop 0
    s_cmp_lg_u32 s59, 7
    s_cbranch_scc1 L_sequential_preLN__sliding_local_dilated__glu_gated_geglu__prompt_kernel_nopub_40
    buffer_store_dword v7, v6, s[64:67], 0 offen sc1
L_sequential_preLN__sliding_local_dilated__glu_gated_geglu__prompt_kernel_nopub_40:
    s_mov_b64 exec, s[60:61]
    s_cmp_lg_u32 s20, 0
    s_cbranch_scc1 L_sequential_preLN__sliding_local_dilated__glu_gated_geglu__prompt_kernel_sync_39
    s_mov_b32 s59, 0
    buffer_load_dword v55, v8, s[64:67], 0 offen sc1
L_sequential_preLN__sliding_local_dilated__glu_gated_geglu__prompt_kernel_poll_41:
    s_sleep 2
    buffer_load_dword v56, v8, s[64:67], 0 offen sc1
    s_waitcnt vmcnt(1)
    v_cmp_ne_u32 vcc, s79, v55
    s_nop 0
    s_cmp_eq_u64 vcc, 0
    s_cbranch_scc1 L_sequential_preLN__sliding_local_dilated__glu_gated_geglu__prompt_kernel_polld_42
    s_sleep 2
    buffer_load_dword v55, v8, s[64:67], 0 offen sc1
    s_waitcnt vmcnt(1)
    v_cmp_ne_u32 vcc, s79, v56
    s_add_u32 s59, s59, 1
    s_cmp_eq_u64 vcc, 0
    s_cbranch_scc1 L_sequential_preLN__sliding_local_dilated__glu_gated_geglu__prompt_kernel_polld_42
    s_cmp_lt_u32 s59, 200000
    s_cbranch_scc1 L_sequential_preLN__sliding_local_dilated__glu_gated_geglu__prompt_kernel_poll_41
L_sequential_preLN__sliding_local_dilated__glu_gated_geglu__prompt_kernel_polld_42:
L_sequential_preLN__sliding_local_dilated__glu_gated_geglu__prompt_kernel_sync_39:
    s_barrier
    v_mov_b32 v2, 7168
    v_mov_b32 v5, 0
    ds_write_b32 v2, v5
    s_add_u32 s16, s82, 4194304
    s_addc_u32 s17, s83, 0
    s_mov_b32 s18, 7340032
    s_mov_b32 s19, 0x00020000
    s_lshl_b32 s25, s74, 7
    s_and_b32 s27, s20, 3
    s_lshr_b32 s28, s20, 2
    v_and_b32 v3, 31, v1
    s_lshl_b32 s29, s27, 5
    v_add_u32 v3, s29, v3
    v_lshrrev_b32 v4, 5, v1
    v_lshrrev_b32 v5, 1, v3
    v_and_b32 v5, 7, v5
    v_xor_b32 v5, v5, v4
    v_lshlrev_b32 v5, 4, v5
    v_lshlrev_b32 v6, 7, v3
    v_add_u32 v5, v6, v5
    v_add_u32 v16, 8192, v5
    v_xor_b32 v17, 32, v16
    v_xor_b32 v18, 64, v16
    v_xor_b32 v19, 0x60, v16
    v_lshrrev_b32 v5, 4, v1
    v_and_b32 v6, 1, v5
    v_lshrrev_b32 v5, 1, v5
    v_and_b32 v7, 15, v1
    v_lshrrev_b32 v8, 2, v7
    v_and_b32 v7, 3, v7
    v_lshlrev_b32 v5, 3, v5
    v_add_u32 v5, v5, v8
    v_mul_u32_u24 v5, 224, v5
    v_mul_u32_u24 v6, 14464, v6
    v_add_u32 v5, v5, v6
    v_lshlrev_b32 v7, 3, v7
    v_add_u32 v5, v5, v7
    v_add_u32 v9, 57344, v5
    v_lshlrev_b32 v5, 5, v3
    v_lshl_add_u32 v5, v4, 4, v5
    s_lshl_b32 s24, s74, 4
    s_add_u32 s24, s24, s75
    s_mul_i32 s24, s24, 28672
    v_add_u32 v24, s24, v5
    s_mov_b32 s55, 0x3f803f80
    s_cmp_eq_u32 s27, 3
    s_cselect_b32 s60, 0, s27
    s_add_u32 s61, s60, 1
    s_cmp_ge_u32 s61, 3
    s_cselect_b32 s54, 3, 0
    s_sub_u32 s61, s61, s54
    s_add_u32 s62, s60, 2
    s_cmp_ge_u32 s62, 3
    s_cselect_b32 s54, 3, 0
    s_sub_u32 s62, s62, s54
    s_add_u32 s60, s60, 4
    s_add_u32 s61, s61, 4
    s_add_u32 s62, s62, 4
    s_add_u32 s51, s27, 1
    s_and_b32 s51, s51, 3
    s_add_u32 s52, s27, 2
    s_and_b32 s52, s52, 3
    s_add_u32 s53, s27, 3
    s_and_b32 s53, s53, 3
    s_cmp_eq_u32 s28, 0
    s_cselect_b32 s50, s27, s60
    s_cselect_b32 s51, s51, s61
    s_cselect_b32 s52, s52, s62
    s_lshl_b32 s24, s50, 5
    v_add_u32 v20, s24, v9
    s_lshl_b32 s24, s51, 5
    v_add_u32 v21, s24, v9
    s_lshl_b32 s24, s52, 5
    v_add_u32 v22, s24, v9
    s_lshl_b32 s24, s53, 5
    v_add_u32 v23, s24, v9
    v_mov_b32 v26, 0
    v_mov_b32 v27, 0
    v_mov_b32 v28, 0
    v_mov_b32 v29, 0
    v_mov_b32 v30, 0
    v_mov_b32 v31, 0
    v_mov_b32 v64, 0
    v_mov_b32 v65, 0
    v_mov_b32 v66, 0
    v_mov_b32 v67, 0
    v_mov_b32 v68, 0
    v_mov_b32 v69, 0
    v_mov_b32 v70, 0
    v_mov_b32 v71, 0
    v_mov_b32 v72, 0
    v_mov_b32 v73, 0
    v_mov_b32 v74, 0
    v_mov_b32 v75, 0
    v_mov_b32 v76, 0
    v_mov_b32 v77, 0
    v_mov_b32 v78, 0
    v_mov_b32 v79, 0
    v_mov_b32 v80, 0
    v_mov_b32 v81, 0
    v_mov_b32 v82, 0
    v_mov_b32 v83, 0
    v_mov_b32 v84, 0
    v_mov_b32 v85, 0
    v_mov_b32 v86, 0
    v_mov_b32 v87, 0
    v_mov_b32 v88, 0
    v_mov_b32 v89, 0
    v_mov_b32 v90, 0
    v_mov_b32 v91, 0
    v_mov_b32 v92, 0
    v_mov_b32 v93, 0
    v_mov_b32 v94, 0
    v_mov_b32 v95, 0
    v_mov_b32 v96, 0
    v_mov_b32 v97, 0
    v_mov_b32 v98, 0
    v_mov_b32 v99, 0
    v_mov_b32 v100, 0
    v_mov_b32 v101, 0
    v_mov_b32 v102, 0
    v_mov_b32 v103, 0
    v_mov_b32 v104, 0
    v_mov_b32 v105, 0
    v_mov_b32 v106, 0
    v_mov_b32 v107, 0
    v_mov_b32 v108, 0
    v_mov_b32 v109, 0
    v_mov_b32 v110, 0
    v_mov_b32 v111, 0
    v_mov_b32 v112, 0
    v_mov_b32 v113, 0
    v_mov_b32 v114, 0
    v_mov_b32 v115, 0
    v_mov_b32 v116, 0
    v_mov_b32 v117, 0
    v_mov_b32 v118, 0
    v_mov_b32 v119, 0
    v_mov_b32 v120, 0
    v_mov_b32 v121, 0
    v_mov_b32 v122, 0
    v_mov_b32 v123, 0
    v_mov_b32 v124, 0
    v_mov_b32 v125, 0
    v_mov_b32 v126, 0
    v_mov_b32 v127, 0
    v_mov_b32 v132, 0
    v_mov_b32 v133, 0
    v_mov_b32 v134, 0
    v_mov_b32 v135, 0
    v_mov_b32 v152, 0
    v_mov_b32 v153, 0
    v_mov_b32 v154, 0
    v_mov_b32 v155, 0
    v_mov_b32 v156, 0
    v_mov_b32 v157, 0
    v_mov_b32 v158, 0
    v_mov_b32 v159, 0
    v_mov_b32 v160, 0
    v_mov_b32 v161, 0
    v_mov_b32 v162, 0
    v_mov_b32 v163, 0
    v_mov_b32 v164, 0
    v_mov_b32 v165, 0
    v_mov_b32 v166, 0
    v_mov_b32 v167, 0
    s_mov_b32 s49, 4294934528
    s_mov_b32 s46, 4294909696
    s_mov_b32 s56, 16384
    s_mov_b32 s45, 28800
    s_mov_b32 s38, 0
    s_mov_b32 s39, 0
    s_cmp_eq_u32 s28, 0
    s_cbranch_scc0 L_sequential_preLN__sliding_local_dilated__glu_gated_geglu__prompt_kernel_p3b_43
    .p2align 6
L_sequential_preLN__sliding_local_dilated__glu_gated_geglu__prompt_kernel_loop3_45:
    s_waitcnt lgkmcnt(0)
    s_barrier
    s_add_u32 s39, s39, 1
    s_cmp_ge_u32 s39, 3
    s_cselect_b32 s48, s49, s56
    s_cselect_b32 s47, s46, s45
    s_cselect_b32 s39, 0, s39
    s_add_u32 s38, s38, 1
    v_mfma_f32_32x32x16_bf16 v[64:79], v[152:155], v[132:135], v[64:79]
    ds_read_b128 v[128:131], v16
    ds_read_b64_tr_b16 v[136:137], v20 offset:0
    ds_read_b64_tr_b16 v[138:139], v20 offset:896
    v_mfma_f32_32x32x16_bf16 v[80:95], v[156:159], v[132:135], v[80:95]
    ds_read_b64_tr_b16 v[140:141], v21 offset:0
    ds_read_b64_tr_b16 v[142:143], v21 offset:896
    v_mfma_f32_32x32x16_bf16 v[96:111], v[160:163], v[132:135], v[96:111]
    ds_read_b64_tr_b16 v[144:145], v22 offset:0
    ds_read_b64_tr_b16 v[146:147], v22 offset:896
    v_mfma_f32_32x32x16_bf16 v[112:127], v[164:167], v[132:135], v[112:127]
    ds_read_b64_tr_b16 v[148:149], v23 offset:0
    ds_read_b64_tr_b16 v[150:151], v23 offset:896
    s_waitcnt lgkmcnt(6)
    v_mfma_f32_32x32x16_bf16 v[64:79], v[136:139], v[128:131], v[64:79]
    ds_read_b128 v[132:135], v17
    ds_read_b64_tr_b16 v[152:153], v20 offset:3584
    ds_read_b64_tr_b16 v[154:155], v20 offset:4480
    s_waitcnt lgkmcnt(7)
    v_mfma_f32_32x32x16_bf16 v[80:95], v[140:143], v[128:131], v[80:95]
    ds_read_b64_tr_b16 v[156:157], v21 offset:3584
    ds_read_b64_tr_b16 v[158:159], v21 offset:4480
    s_waitcnt lgkmcnt(7)
    v_mfma_f32_32x32x16_bf16 v[96:111], v[144:147], v[128:131], v[96:111]
    ds_read_b64_tr_b16 v[160:161], v22 offset:3584
    ds_read_b64_tr_b16 v[162:163], v22 offset:4480
    s_waitcnt lgkmcnt(7)
    v_mfma_f32_32x32x16_bf16 v[112:127], v[148:151], v[128:131], v[112:127]
    ds_read_b64_tr_b16 v[164:165], v23 offset:3584
    ds_read_b64_tr_b16 v[166:167], v23 offset:4480
    s_waitcnt lgkmcnt(6)
    v_mfma_f32_32x32x16_bf16 v[64:79], v[152:155], v[132:135], v[64:79]
    ds_read_b128 v[128:131], v18
    ds_read_b64_tr_b16 v[136:137], v20 offset:7168
    ds_read_b64_tr_b16 v[138:139], v20 offset:8064
    s_waitcnt lgkmcnt(7)
    v_mfma_f32_32x32x16_bf16 v[80:95], v[156:159], v[132:135], v[80:95]
    ds_read_b64_tr_b16 v[140:141], v21 offset:7168
    ds_read_b64_tr_b16 v[142:143], v21 offset:8064
    s_waitcnt lgkmcnt(7)
    v_mfma_f32_32x32x16_bf16 v[96:111], v[160:163], v[132:135], v[96:111]
    ds_read_b64_tr_b16 v[144:145], v22 offset:7168
    ds_read_b64_tr_b16 v[146:147], v22 offset:8064
    s_waitcnt lgkmcnt(7)
    v_mfma_f32_32x32x16_bf16 v[112:127], v[164:167], v[132:135], v[112:127]
    ds_read_b64_tr_b16 v[148:149], v23 offset:7168
    ds_read_b64_tr_b16 v[150:151], v23 offset:8064
    s_waitcnt lgkmcnt(6)
    v_mfma_f32_32x32x16_bf16 v[64:79], v[136:139], v[128:131], v[64:79]
    ds_read_b128 v[132:135], v19
    ds_read_b64_tr_b16 v[152:153], v20 offset:10752
    ds_read_b64_tr_b16 v[154:155], v20 offset:11648
    s_waitcnt lgkmcnt(7)
    v_mfma_f32_32x32x16_bf16 v[80:95], v[140:143], v[128:131], v[80:95]
    ds_read_b64_tr_b16 v[156:157], v21 offset:10752
    ds_read_b64_tr_b16 v[158:159], v21 offset:11648
    s_waitcnt lgkmcnt(7)
    v_mfma_f32_32x32x16_bf16 v[96:111], v[144:147], v[128:131], v[96:111]
    ds_read_b64_tr_b16 v[160:161], v22 offset:10752
    ds_read_b64_tr_b16 v[162:163], v22 offset:11648
    s_waitcnt lgkmcnt(7)
    v_mfma_f32_32x32x16_bf16 v[112:127], v[148:151], v[128:131], v[112:127]
    ds_read_b64_tr_b16 v[164:165], v23 offset:10752
    ds_read_b64_tr_b16 v[166:167], v23 offset:11648
    v_add_u32 v16, s48, v16
    v_add_u32 v17, s48, v17
    v_add_u32 v18, s48, v18
    v_add_u32 v19, s48, v19
    v_add_u32 v20, s47, v20
    v_add_u32 v21, s47, v21
    v_add_u32 v22, s47, v22
    v_add_u32 v23, s47, v23
    s_cmp_lt_u32 s38, 8
    s_cbranch_scc1 L_sequential_preLN__sliding_local_dilated__glu_gated_geglu__prompt_kernel_loop3_45
    s_waitcnt lgkmcnt(0)
    v_mfma_f32_32x32x16_bf16 v[64:79], v[152:155], v[132:135], v[64:79]
    v_mfma_f32_32x32x16_bf16 v[80:95], v[156:159], v[132:135], v[80:95]
    v_mfma_f32_32x32x16_bf16 v[96:111], v[160:163], v[132:135], v[96:111]
    v_mfma_f32_32x32x16_bf16 v[112:127], v[164:167], v[132:135], v[112:127]
    s_branch L_sequential_preLN__sliding_local_dilated__glu_gated_geglu__prompt_kernel_p3e_44
L_sequential_preLN__sliding_local_dilated__glu_gated_geglu__prompt_kernel_p3b_43:
    .p2align 6
L_sequential_preLN__sliding_local_dilated__glu_gated_geglu__prompt_kernel_loop3_46:
    s_waitcnt lgkmcnt(0)
    s_barrier
    s_add_u32 s39, s39, 1
    s_cmp_ge_u32 s39, 3
    s_cselect_b32 s48, s49, s56
    s_cselect_b32 s47, s46, s45
    s_cselect_b32 s39, 0, s39
    s_add_u32 s38, s38, 1
    v_mfma_f32_32x32x16_bf16 v[64:79], v[152:155], v[132:135], v[64:79]
    ds_read_b128 v[128:131], v16
    ds_read_b64_tr_b16 v[136:137], v20 offset:0
    ds_read_b64_tr_b16 v[138:139], v20 offset:896
    v_mfma_f32_32x32x16_bf16 v[80:95], v[156:159], v[132:135], v[80:95]
    ds_read_b64_tr_b16 v[140:141], v21 offset:0
    ds_read_b64_tr_b16 v[142:143], v21 offset:896
    v_mfma_f32_32x32x16_bf16 v[96:111], v[160:163], v[132:135], v[96:111]
    ds_read_b64_tr_b16 v[144:145], v22 offset:0
    ds_read_b64_tr_b16 v[146:147], v22 offset:896
    s_waitcnt lgkmcnt(4)
    v_mfma_f32_32x32x16_bf16 v[64:79], v[136:139], v[128:131], v[64:79]
    ds_read_b128 v[132:135], v17
    ds_read_b64_tr_b16 v[152:153], v20 offset:3584
    ds_read_b64_tr_b16 v[154:155], v20 offset:4480
    s_waitcnt lgkmcnt(5)
    v_mfma_f32_32x32x16_bf16 v[80:95], v[140:143], v[128:131], v[80:95]
    ds_read_b64_tr_b16 v[156:157], v21 offset:3584
    ds_read_b64_tr_b16 v[158:159], v21 offset:4480
    s_waitcnt lgkmcnt(5)
    v_mfma_f32_32x32x16_bf16 v[96:111], v[144:147], v[128:131], v[96:111]
    ds_read_b64_tr_b16 v[160:161], v22 offset:3584
    ds_read_b64_tr_b16 v[162:163], v22 offset:4480
    s_waitcnt lgkmcnt(4)
    v_mfma_f32_32x32x16_bf16 v[64:79], v[152:155], v[132:135], v[64:79]
    ds_read_b128 v[128:131], v18
    ds_read_b64_tr_b16 v[136:137], v20 offset:7168
    ds_read_b64_tr_b16 v[138:139], v20 offset:8064
    s_waitcnt lgkmcnt(5)
    v_mfma_f32_32x32x16_bf16 v[80:95], v[156:159], v[132:135], v[80:95]
    ds_read_b64_tr_b16 v[140:141], v21 offset:7168
    ds_read_b64_tr_b16 v[142:143], v21 offset:8064
    s_waitcnt lgkmcnt(5)
    v_mfma_f32_32x32x16_bf16 v[96:111], v[160:163], v[132:135], v[96:111]
    ds_read_b64_tr_b16 v[144:145], v22 offset:7168
    ds_read_b64_tr_b16 v[146:147], v22 offset:8064
    s_waitcnt lgkmcnt(4)
    v_mfma_f32_32x32x16_bf16 v[64:79], v[136:139], v[128:131], v[64:79]
    ds_read_b128 v[132:135], v19
    ds_read_b64_tr_b16 v[152:153], v20 offset:10752
    ds_read_b64_tr_b16 v[154:155], v20 offset:11648
    s_waitcnt lgkmcnt(5)
    v_mfma_f32_32x32x16_bf16 v[80:95], v[140:143], v[128:131], v[80:95]
    ds_read_b64_tr_b16 v[156:157], v21 offset:10752
    ds_read_b64_tr_b16 v[158:159], v21 offset:11648
    s_waitcnt lgkmcnt(5)
    v_mfma_f32_32x32x16_bf16 v[96:111], v[144:147], v[128:131], v[96:111]
    ds_read_b64_tr_b16 v[160:161], v22 offset:10752
    ds_read_b64_tr_b16 v[162:163], v22 offset:11648
    v_add_u32 v16, s48, v16
    v_add_u32 v17, s48, v17
    v_add_u32 v18, s48, v18
    v_add_u32 v19, s48, v19
    v_add_u32 v20, s47, v20
    v_add_u32 v21, s47, v21
    v_add_u32 v22, s47, v22
    s_cmp_lt_u32 s38, 8
    s_cbranch_scc1 L_sequential_preLN__sliding_local_dilated__glu_gated_geglu__prompt_kernel_loop3_46
    s_waitcnt lgkmcnt(0)
    v_mfma_f32_32x32x16_bf16 v[64:79], v[152:155], v[132:135], v[64:79]
    v_mfma_f32_32x32x16_bf16 v[80:95], v[156:159], v[132:135], v[80:95]
    v_mfma_f32_32x32x16_bf16 v[96:111], v[160:163], v[132:135], v[96:111]
L_sequential_preLN__sliding_local_dilated__glu_gated_geglu__prompt_kernel_p3e_44:
    s_barrier
    v_lshlrev_b32 v33, 3, v3
    v_add_u32 v33, 4096, v33
    ds_read_b64 v[30:31], v33
    s_lshl_b32 s24, s50, 5
    s_add_u32 s24, s24, -16384
    v_add_u32 v20, s24, v9
    s_lshl_b32 s24, s51, 5
    s_add_u32 s24, s24, -16384
    v_add_u32 v21, s24, v9
    s_lshl_b32 s24, s52, 5
    s_add_u32 s24, s24, -16384
    v_add_u32 v22, s24, v9
    s_lshl_b32 s24, s53, 5
    s_add_u32 s24, s24, -16384
    v_add_u32 v23, s24, v9
    ds_read_b64_tr_b16 v[136:137], v20
    ds_read_b64_tr_b16 v[138:139], v20 offset:896
    ds_read_b64_tr_b16 v[140:141], v21
    ds_read_b64_tr_b16 v[142:143], v21 offset:896
    ds_read_b64_tr_b16 v[144:145], v22
    ds_read_b64_tr_b16 v[146:147], v22 offset:896
    ds_read_b64_tr_b16 v[148:149], v23
    ds_read_b64_tr_b16 v[150:151], v23 offset:896
    s_waitcnt lgkmcnt(8)
    v_xor_b32 v30, 0x80000000, v30
    v_lshrrev_b32 v129, 16, v30
    v_or_b32 v128, v129, v30
    v_cmp_eq_u32 vcc, 0, v4
    s_nop 1
    v_cndmask_b32 v128, 0, v128, vcc
    v_cndmask_b32 v129, 0, v129, vcc
    v_mov_b32 v130, 0
    v_mov_b32 v131, 0
    v_mul_f32 v32, v31, v31
    v_mul_f32 v34, 3222493025, v31
    v_mul_f32 v35, v32, v31
    v_mul_f32 v35, 3184710632, v35
    v_rcp_f32 v36, v32
    s_waitcnt lgkmcnt(0)
    v_mfma_f32_32x32x16_bf16 v[64:79], v[136:139], v[128:131], v[64:79]
    v_mfma_f32_32x32x16_bf16 v[80:95], v[140:143], v[128:131], v[80:95]
    v_mfma_f32_32x32x16_bf16 v[96:111], v[144:147], v[128:131], v[96:111]
    v_mfma_f32_32x32x16_bf16 v[112:127], v[148:151], v[128:131], v[112:127]
    s_nop 8
    v_mul_f32 v144, v64, v64
    v_mul_f32 v145, v65, v65
    v_mul_f32 v146, v66, v66
    v_mul_f32 v147, v67, v67
    v_mul_f32 v148, v68, v68
    v_mul_f32 v149, v69, v69
    v_mul_f32 v150, v70, v70
    v_mul_f32 v151, v71, v71
    v_fma_f32 v144, v144, v35, v34
    v_fma_f32 v145, v145, v35, v34
    v_fma_f32 v146, v146, v35, v34
    v_fma_f32 v147, v147, v35, v34
    v_fma_f32 v148, v148, v35, v34
    v_fma_f32 v149, v149, v35, v34
    v_fma_f32 v150, v150, v35, v34
    v_fma_f32 v151, v151, v35, v34
    v_mul_f32 v144, v64, v144
    v_mul_f32 v145, v65, v145
    v_mul_f32 v146, v66, v146
    v_mul_f32 v147, v67, v147
    v_mul_f32 v148, v68, v148
    v_mul_f32 v149, v69, v149
    v_mul_f32 v150, v70, v150
    v_mul_f32 v151, v71, v151
    v_exp_f32 v144, v144
    v_exp_f32 v145, v145
    v_exp_f32 v146, v146
    v_exp_f32 v147, v147
    v_exp_f32 v148, v148
    v_exp_f32 v149, v149
    v_exp_f32 v150, v150
    v_exp_f32 v151, v151
    v_mul_f32 v64, v64, v72
    v_mul_f32 v65, v65, v73
    v_mul_f32 v66, v66, v74
    v_mul_f32 v67, v67, v75
    v_mul_f32 v68, v68, v76
    v_mul_f32 v69, v69, v77
    v_mul_f32 v70, v70, v78
    v_mul_f32 v71, v71, v79
    v_fma_f32 v144, v144, v36, v36
    v_fma_f32 v145, v145, v36, v36
    v_fma_f32 v146, v146, v36, v36
    v_fma_f32 v147, v147, v36, v36
    v_fma_f32 v148, v148, v36, v36
    v_fma_f32 v149, v149, v36, v36
    v_fma_f32 v150, v150, v36, v36
    v_fma_f32 v151, v151, v36, v36
    v_rcp_f32 v144, v144
    v_rcp_f32 v145, v145
    v_rcp_f32 v146, v146
    v_rcp_f32 v147, v147
    v_rcp_f32 v148, v148
    v_rcp_f32 v149, v149
    v_rcp_f32 v150, v150
    v_rcp_f32 v151, v151
    s_lshl_b32 s57, s50, 12
    v_mul_f32 v64, v64, v144
    v_mul_f32 v65, v65, v145
    v_mul_f32 v66, v66, v146
    v_mul_f32 v67, v67, v147
    v_mul_f32 v68, v68, v148
    v_mul_f32 v69, v69, v149
    v_mul_f32 v70, v70, v150
    v_mul_f32 v71, v71, v151
    v_cvt_pk_bf16_f32 v160, v64, v65
    v_cvt_pk_bf16_f32 v161, v66, v67
    v_cvt_pk_bf16_f32 v162, v68, v69
    v_cvt_pk_bf16_f32 v163, v70, v71
    s_nop 0
    v_permlane32_swap_b32 v160, v162
    v_permlane32_swap_b32 v161, v163
    buffer_store_dwordx4 v[160:163], v24, s[16:19], s57 offen sc1
    v_mul_f32 v144, v80, v80
    v_mul_f32 v145, v81, v81
    v_mul_f32 v146, v82, v82
    v_mul_f32 v147, v83, v83
    v_mul_f32 v148, v84, v84
    v_mul_f32 v149, v85, v85
    v_mul_f32 v150, v86, v86
    v_mul_f32 v151, v87, v87
    v_fma_f32 v144, v144, v35, v34
    v_fma_f32 v145, v145, v35, v34
    v_fma_f32 v146, v146, v35, v34
    v_fma_f32 v147, v147, v35, v34
    v_fma_f32 v148, v148, v35, v34
    v_fma_f32 v149, v149, v35, v34
    v_fma_f32 v150, v150, v35, v34
    v_fma_f32 v151, v151, v35, v34
    v_mul_f32 v144, v80, v144
    v_mul_f32 v145, v81, v145
    v_mul_f32 v146, v82, v146
    v_mul_f32 v147, v83, v147
    v_mul_f32 v148, v84, v148
    v_mul_f32 v149, v85, v149
    v_mul_f32 v150, v86, v150
    v_mul_f32 v151, v87, v151
    v_exp_f32 v144, v144
    v_exp_f32 v145, v145
    v_exp_f32 v146, v146
    v_exp_f32 v147, v147
    v_exp_f32 v148, v148
    v_exp_f32 v149, v149
    v_exp_f32 v150, v150
    v_exp_f32 v151, v151
    v_mul_f32 v80, v80, v88
    v_mul_f32 v81, v81, v89
    v_mul_f32 v82, v82, v90
    v_mul_f32 v83, v83, v91
    v_mul_f32 v84, v84, v92
    v_mul_f32 v85, v85, v93
    v_mul_f32 v86, v86, v94
    v_mul_f32 v87, v87, v95
    v_fma_f32 v144, v144, v36, v36
    v_fma_f32 v145, v145, v36, v36
    v_fma_f32 v146, v146, v36, v36
    v_fma_f32 v147, v147, v36, v36
    v_fma_f32 v148, v148, v36, v36
    v_fma_f32 v149, v149, v36, v36
    v_fma_f32 v150, v150, v36, v36
    v_fma_f32 v151, v151, v36, v36
    v_rcp_f32 v144, v144
    v_rcp_f32 v145, v145
    v_rcp_f32 v146, v146
    v_rcp_f32 v147, v147
    v_rcp_f32 v148, v148
    v_rcp_f32 v149, v149
    v_rcp_f32 v150, v150
    v_rcp_f32 v151, v151
    s_lshl_b32 s57, s51, 12
    v_mul_f32 v80, v80, v144
    v_mul_f32 v81, v81, v145
    v_mul_f32 v82, v82, v146
    v_mul_f32 v83, v83, v147
    v_mul_f32 v84, v84, v148
    v_mul_f32 v85, v85, v149
    v_mul_f32 v86, v86, v150
    v_mul_f32 v87, v87, v151
    v_cvt_pk_bf16_f32 v160, v80, v81
    v_cvt_pk_bf16_f32 v161, v82, v83
    v_cvt_pk_bf16_f32 v162, v84, v85
    v_cvt_pk_bf16_f32 v163, v86, v87
    s_nop 0
    v_permlane32_swap_b32 v160, v162
    v_permlane32_swap_b32 v161, v163
    buffer_store_dwordx4 v[160:163], v24, s[16:19], s57 offen sc1
    v_mul_f32 v144, v96, v96
    v_mul_f32 v145, v97, v97
    v_mul_f32 v146, v98, v98
    v_mul_f32 v147, v99, v99
    v_mul_f32 v148, v100, v100
    v_mul_f32 v149, v101, v101
    v_mul_f32 v150, v102, v102
    v_mul_f32 v151, v103, v103
    v_fma_f32 v144, v144, v35, v34
    v_fma_f32 v145, v145, v35, v34
    v_fma_f32 v146, v146, v35, v34
    v_fma_f32 v147, v147, v35, v34
    v_fma_f32 v148, v148, v35, v34
    v_fma_f32 v149, v149, v35, v34
    v_fma_f32 v150, v150, v35, v34
    v_fma_f32 v151, v151, v35, v34
    v_mul_f32 v144, v96, v144
    v_mul_f32 v145, v97, v145
    v_mul_f32 v146, v98, v146
    v_mul_f32 v147, v99, v147
    v_mul_f32 v148, v100, v148
    v_mul_f32 v149, v101, v149
    v_mul_f32 v150, v102, v150
    v_mul_f32 v151, v103, v151
    v_exp_f32 v144, v144
    v_exp_f32 v145, v145
    v_exp_f32 v146, v146
    v_exp_f32 v147, v147
    v_exp_f32 v148, v148
    v_exp_f32 v149, v149
    v_exp_f32 v150, v150
    v_exp_f32 v151, v151
    v_mul_f32 v96, v96, v104
    v_mul_f32 v97, v97, v105
    v_mul_f32 v98, v98, v106
    v_mul_f32 v99, v99, v107
    v_mul_f32 v100, v100, v108
    v_mul_f32 v101, v101, v109
    v_mul_f32 v102, v102, v110
    v_mul_f32 v103, v103, v111
    v_fma_f32 v144, v144, v36, v36
    v_fma_f32 v145, v145, v36, v36
    v_fma_f32 v146, v146, v36, v36
    v_fma_f32 v147, v147, v36, v36
    v_fma_f32 v148, v148, v36, v36
    v_fma_f32 v149, v149, v36, v36
    v_fma_f32 v150, v150, v36, v36
    v_fma_f32 v151, v151, v36, v36
    v_rcp_f32 v144, v144
    v_rcp_f32 v145, v145
    v_rcp_f32 v146, v146
    v_rcp_f32 v147, v147
    v_rcp_f32 v148, v148
    v_rcp_f32 v149, v149
    v_rcp_f32 v150, v150
    v_rcp_f32 v151, v151
    s_lshl_b32 s57, s52, 12
    v_mul_f32 v96, v96, v144
    v_mul_f32 v97, v97, v145
    v_mul_f32 v98, v98, v146
    v_mul_f32 v99, v99, v147
    v_mul_f32 v100, v100, v148
    v_mul_f32 v101, v101, v149
    v_mul_f32 v102, v102, v150
    v_mul_f32 v103, v103, v151
    v_cvt_pk_bf16_f32 v160, v96, v97
    v_cvt_pk_bf16_f32 v161, v98, v99
    v_cvt_pk_bf16_f32 v162, v100, v101
    v_cvt_pk_bf16_f32 v163, v102, v103
    s_nop 0
    v_permlane32_swap_b32 v160, v162
    v_permlane32_swap_b32 v161, v163
    buffer_store_dwordx4 v[160:163], v24, s[16:19], s57 offen sc1
    s_cmp_eq_u32 s28, 1
    s_cbranch_scc1 L_sequential_preLN__sliding_local_dilated__glu_gated_geglu__prompt_kernel_skq_50
    v_mul_f32 v144, v112, v112
    v_mul_f32 v145, v113, v113
    v_mul_f32 v146, v114, v114
    v_mul_f32 v147, v115, v115
    v_mul_f32 v148, v116, v116
    v_mul_f32 v149, v117, v117
    v_mul_f32 v150, v118, v118
    v_mul_f32 v151, v119, v119
    v_fma_f32 v144, v144, v35, v34
    v_fma_f32 v145, v145, v35, v34
    v_fma_f32 v146, v146, v35, v34
    v_fma_f32 v147, v147, v35, v34
    v_fma_f32 v148, v148, v35, v34
    v_fma_f32 v149, v149, v35, v34
    v_fma_f32 v150, v150, v35, v34
    v_fma_f32 v151, v151, v35, v34
    v_mul_f32 v144, v112, v144
    v_mul_f32 v145, v113, v145
    v_mul_f32 v146, v114, v146
    v_mul_f32 v147, v115, v147
    v_mul_f32 v148, v116, v148
    v_mul_f32 v149, v117, v149
    v_mul_f32 v150, v118, v150
    v_mul_f32 v151, v119, v151
    v_exp_f32 v144, v144
    v_exp_f32 v145, v145
    v_exp_f32 v146, v146
    v_exp_f32 v147, v147
    v_exp_f32 v148, v148
    v_exp_f32 v149, v149
    v_exp_f32 v150, v150
    v_exp_f32 v151, v151
    v_mul_f32 v112, v112, v120
    v_mul_f32 v113, v113, v121
    v_mul_f32 v114, v114, v122
    v_mul_f32 v115, v115, v123
    v_mul_f32 v116, v116, v124
    v_mul_f32 v117, v117, v125
    v_mul_f32 v118, v118, v126
    v_mul_f32 v119, v119, v127
    v_fma_f32 v144, v144, v36, v36
    v_fma_f32 v145, v145, v36, v36
    v_fma_f32 v146, v146, v36, v36
    v_fma_f32 v147, v147, v36, v36
    v_fma_f32 v148, v148, v36, v36
    v_fma_f32 v149, v149, v36, v36
    v_fma_f32 v150, v150, v36, v36
    v_fma_f32 v151, v151, v36, v36
    v_rcp_f32 v144, v144
    v_rcp_f32 v145, v145
    v_rcp_f32 v146, v146
    v_rcp_f32 v147, v147
    v_rcp_f32 v148, v148
    v_rcp_f32 v149, v149
    v_rcp_f32 v150, v150
    v_rcp_f32 v151, v151
    s_lshl_b32 s57, s53, 12
    v_mul_f32 v112, v112, v144
    v_mul_f32 v113, v113, v145
    v_mul_f32 v114, v114, v146
    v_mul_f32 v115, v115, v147
    v_mul_f32 v116, v116, v148
    v_mul_f32 v117, v117, v149
    v_mul_f32 v118, v118, v150
    v_mul_f32 v119, v119, v151
    v_cvt_pk_bf16_f32 v160, v112, v113
    v_cvt_pk_bf16_f32 v161, v114, v115
    v_cvt_pk_bf16_f32 v162, v116, v117
    v_cvt_pk_bf16_f32 v163, v118, v119
    s_nop 0
    v_permlane32_swap_b32 v160, v162
    v_permlane32_swap_b32 v161, v163
    buffer_store_dwordx4 v[160:163], v24, s[16:19], s57 offen sc1
L_sequential_preLN__sliding_local_dilated__glu_gated_geglu__prompt_kernel_skq_50:
    v_mov_b32 v2, 7168
    v_mov_b32 v5, 1
    s_lshl_b32 s59, s74, 7
    s_add_u32 s59, s59, 16384
    s_lshl_b32 s58, s75, 2
    s_add_u32 s59, s59, s58
    s_lshl_b32 s59, s59, 5
    v_mov_b32 v6, s59
    v_mov_b32 v7, s79
    s_lshr_b32 s58, s76, 1
    s_lshl_b32 s58, s58, 7
    s_add_u32 s58, s58, 16384
    v_and_b32 v8, 15, v1
    v_lshlrev_b32 v8, 7, v8
    s_lshl_b32 s58, s58, 5
    v_add_u32 v8, s58, v8
    s_waitcnt vmcnt(0)
    s_mov_b64 s[60:61], exec
    s_mov_b64 exec, 1
    ds_add_rtn_u32 v5, v2, v5
    s_waitcnt lgkmcnt(0)
    v_readfirstlane_b32 s59, v5
    s_nop 0
    s_cmp_lg_u32 s59, 7
    s_cbranch_scc1 L_sequential_preLN__sliding_local_dilated__glu_gated_geglu__prompt_kernel_nopub_52
    buffer_store_dword v7, v6, s[64:67], 0 offen sc1
L_sequential_preLN__sliding_local_dilated__glu_gated_geglu__prompt_kernel_nopub_52:
    s_mov_b64 exec, s[60:61]
    s_cmp_lg_u32 s20, 0
    s_cbranch_scc1 L_sequential_preLN__sliding_local_dilated__glu_gated_geglu__prompt_kernel_sync_51
    s_mov_b32 s59, 0
    buffer_load_dword v55, v8, s[64:67], 0 offen sc1
L_sequential_preLN__sliding_local_dilated__glu_gated_geglu__prompt_kernel_poll_53:
    s_sleep 2
    buffer_load_dword v56, v8, s[64:67], 0 offen sc1
    s_waitcnt vmcnt(1)
    v_cmp_ne_u32 vcc, s79, v55
    s_nop 0
    s_cmp_eq_u64 vcc, 0
    s_cbranch_scc1 L_sequential_preLN__sliding_local_dilated__glu_gated_geglu__prompt_kernel_polld_54
    s_sleep 2
    buffer_load_dword v55, v8, s[64:67], 0 offen sc1
    s_waitcnt vmcnt(1)
    v_cmp_ne_u32 vcc, s79, v56
    s_add_u32 s59, s59, 1
    s_cmp_eq_u64 vcc, 0
    s_cbranch_scc1 L_sequential_preLN__sliding_local_dilated__glu_gated_geglu__prompt_kernel_polld_54
    s_cmp_lt_u32 s59, 200000
    s_cbranch_scc1 L_sequential_preLN__sliding_local_dilated__glu_gated_geglu__prompt_kernel_poll_53
L_sequential_preLN__sliding_local_dilated__glu_gated_geglu__prompt_kernel_polld_54:
L_sequential_preLN__sliding_local_dilated__glu_gated_geglu__prompt_kernel_sync_51:
    s_barrier
    s_and_b32 s27, s20, 1
    s_lshr_b32 s28, s20, 1
    s_and_b32 s28, s28, 1
    s_lshr_b32 s29, s20, 2
    v_and_b32 v3, 31, v1
    s_lshl_b32 s24, s27, 5
    v_add_u32 v3, s24, v3
    v_lshrrev_b32 v4, 5, v1
    v_lshrrev_b32 v5, 4, v1
    v_and_b32 v6, 1, v5
    v_lshrrev_b32 v5, 1, v5
    v_and_b32 v7, 15, v1
    v_lshrrev_b32 v8, 2, v7
    v_and_b32 v7, 3, v7
    v_lshl_add_u32 v5, v5, 3, v8
    v_lshlrev_b32 v5, 7, v5
    v_lshrrev_b32 v8, 1, v8
    v_xor_b32 v8, s28, v8
    v_lshl_add_u32 v5, v8, 6, v5
    v_lshl_add_u32 v5, v6, 5, v5
    v_lshl_add_u32 v9, v7, 3, v5
    v_mov_b32 v32, 0
    v_mov_b32 v33, 0
    v_mov_b32 v34, 0
    v_mov_b32 v35, 0
    v_mov_b32 v36, 0
    v_mov_b32 v37, 0
    v_mov_b32 v38, 0
    v_mov_b32 v39, 0
    v_mov_b32 v40, 0
    v_mov_b32 v41, 0
    v_mov_b32 v42, 0
    v_mov_b32 v43, 0
    v_mov_b32 v44, 0
    v_mov_b32 v45, 0
    v_mov_b32 v46, 0
    v_mov_b32 v47, 0
    v_mov_b32 v96, 0
    v_mov_b32 v97, 0
    v_mov_b32 v98, 0
    v_mov_b32 v99, 0
    v_mov_b32 v100, 0
    v_mov_b32 v101, 0
    v_mov_b32 v102, 0
    v_mov_b32 v103, 0
    v_mov_b32 v104, 0
    v_mov_b32 v105, 0
    v_mov_b32 v106, 0
    v_mov_b32 v107, 0
    v_mov_b32 v108, 0
    v_mov_b32 v109, 0
    v_mov_b32 v110, 0
    v_mov_b32 v111, 0
    v_bfe_u32 v5, v3, 3, 1
    v_xor_b32 v5, v5, v4
    v_lshlrev_b32 v5, 4, v5
    v_lshl_add_u32 v5, v3, 5, v5
    s_lshl_b32 s24, s29, 13
    s_add_u32 s24, s24, 8192
    v_add_u32 v10, s24, v5
    s_lshl_b32 s24, s29, 13
    s_add_u32 s24, s24, 81920
    v_add_u32 v14, s24, v9
    s_mov_b32 s49, 4294909952
    s_mov_b32 s56, 14336
    s_mov_b32 s38, 0
    s_mov_b32 s39, 0
    s_mov_b32 s16, s98
    s_mov_b32 s17, s99
    s_mov_b32 s18, 2097152
    s_mov_b32 s19, 0x00020000
    v_mul_u32_u24 v5, 272, v3
    v_lshl_add_u32 v5, v4, 4, v5
    s_mul_i32 s24, s29, 17408
    s_lshl_b32 s30, s28, 7
    s_add_u32 s24, s24, s30
    s_add_u32 s24, s24, 22528
    v_add_u32 v16, s24, v5
    v_lshrrev_b32 v6, 3, v0
    v_mul_u32_u24 v5, 272, v6
    v_and_b32 v7, 7, v0
    v_lshl_add_u32 v5, v7, 5, v5
    v_add_u32 v17, 22528, v5
    s_cmp_eq_u32 s29, 0
    s_cbranch_scc0 L_sequential_preLN__sliding_local_dilated__glu_gated_geglu__prompt_kernel_p4b_55
    .p2align 6
L_sequential_preLN__sliding_local_dilated__glu_gated_geglu__prompt_kernel_gloop_57:
    s_waitcnt lgkmcnt(0)
    s_barrier
    ds_read_b128 v[80:83], v10 offset:0
    ds_read_b64_tr_b16 v[84:85], v14 offset:0
    ds_read_b64_tr_b16 v[86:87], v14 offset:512
    ds_read_b128 v[88:91], v10 offset:2048
    ds_read_b64_tr_b16 v[92:93], v14 offset:2048
    ds_read_b64_tr_b16 v[94:95], v14 offset:2560
    s_add_u32 s39, s39, 1
    s_cmp_ge_u32 s39, 5
    s_cselect_b32 s48, s49, s56
    s_cselect_b32 s39, 0, s39
    s_add_u32 s38, s38, 1
    v_mfma_f32_32x32x16_bf16 v[32:47], v[100:103], v[96:99], v[32:47]
    v_mfma_f32_32x32x16_bf16 v[32:47], v[108:111], v[104:107], v[32:47]
    ds_read_b128 v[96:99], v10 offset:4096
    ds_read_b64_tr_b16 v[100:101], v14 offset:4096
    ds_read_b64_tr_b16 v[102:103], v14 offset:4608
    ds_read_b128 v[104:107], v10 offset:6144
    ds_read_b64_tr_b16 v[108:109], v14 offset:6144
    ds_read_b64_tr_b16 v[110:111], v14 offset:6656
    s_waitcnt lgkmcnt(6)
    v_mfma_f32_32x32x16_bf16 v[32:47], v[84:87], v[80:83], v[32:47]
    v_mfma_f32_32x32x16_bf16 v[32:47], v[92:95], v[88:91], v[32:47]
    v_add_u32 v10, s48, v10
    v_add_u32 v14, s48, v14
    s_cmp_lt_u32 s38, 16
    s_cbranch_scc1 L_sequential_preLN__sliding_local_dilated__glu_gated_geglu__prompt_kernel_gloop_57
    s_waitcnt lgkmcnt(0)
    v_mfma_f32_32x32x16_bf16 v[32:47], v[100:103], v[96:99], v[32:47]
    v_mfma_f32_32x32x16_bf16 v[32:47], v[108:111], v[104:107], v[32:47]
    s_branch L_sequential_preLN__sliding_local_dilated__glu_gated_geglu__prompt_kernel_p4e_56
L_sequential_preLN__sliding_local_dilated__glu_gated_geglu__prompt_kernel_p4b_55:
    .p2align 6
L_sequential_preLN__sliding_local_dilated__glu_gated_geglu__prompt_kernel_gloop_58:
    s_waitcnt lgkmcnt(0)
    s_barrier
    ds_read_b128 v[80:83], v10 offset:0
    ds_read_b64_tr_b16 v[84:85], v14 offset:0
    ds_read_b64_tr_b16 v[86:87], v14 offset:512
    ds_read_b128 v[88:91], v10 offset:2048
    ds_read_b64_tr_b16 v[92:93], v14 offset:2048
    ds_read_b64_tr_b16 v[94:95], v14 offset:2560
    s_add_u32 s39, s39, 1
    s_cmp_ge_u32 s39, 5
    s_cselect_b32 s48, s49, s56
    s_cselect_b32 s39, 0, s39
    s_add_u32 s38, s38, 1
    v_mfma_f32_32x32x16_bf16 v[32:47], v[100:103], v[96:99], v[32:47]
    ds_read_b128 v[96:99], v10 offset:4096
    ds_read_b64_tr_b16 v[100:101], v14 offset:4096
    ds_read_b64_tr_b16 v[102:103], v14 offset:4608
    s_waitcnt lgkmcnt(3)
    v_mfma_f32_32x32x16_bf16 v[32:47], v[84:87], v[80:83], v[32:47]
    v_mfma_f32_32x32x16_bf16 v[32:47], v[92:95], v[88:91], v[32:47]
    v_add_u32 v10, s48, v10
    v_add_u32 v14, s48, v14
    s_cmp_lt_u32 s38, 16
    s_cbranch_scc1 L_sequential_preLN__sliding_local_dilated__glu_gated_geglu__prompt_kernel_gloop_58
    s_waitcnt lgkmcnt(0)
    v_mfma_f32_32x32x16_bf16 v[32:47], v[100:103], v[96:99], v[32:47]
L_sequential_preLN__sliding_local_dilated__glu_gated_geglu__prompt_kernel_p4e_56:
    s_nop 11
    ds_write_b128 v16, v[32:35] offset:0
    ds_write_b128 v16, v[36:39] offset:32
    ds_write_b128 v16, v[40:43] offset:64
    ds_write_b128 v16, v[44:47] offset:96
    s_waitcnt vmcnt(0)
    v_lshlrev_b32 v64, 16, v58
    v_and_b32 v65, 0xffff0000, v58
    v_lshlrev_b32 v66, 16, v59
    v_and_b32 v67, 0xffff0000, v59
    v_lshlrev_b32 v68, 16, v60
    v_and_b32 v69, 0xffff0000, v60
    v_lshlrev_b32 v70, 16, v61
    v_and_b32 v71, 0xffff0000, v61
    s_waitcnt lgkmcnt(0)
    s_barrier
    ds_read_b128 v[32:35], v17
    ds_read_b128 v[40:43], v17 offset:17408
    ds_read_b128 v[36:39], v17 offset:16
    ds_read_b128 v[44:47], v17 offset:17424
    s_waitcnt lgkmcnt(2)
    v_add_f32 v32, v32, v40
    v_add_f32 v33, v33, v41
    v_add_f32 v34, v34, v42
    v_add_f32 v35, v35, v43
    v_add_f32 v32, v32, v64
    v_add_f32 v33, v33, v65
    v_add_f32 v34, v34, v66
    v_add_f32 v35, v35, v67
    s_waitcnt lgkmcnt(0)
    v_add_f32 v36, v36, v44
    v_add_f32 v37, v37, v45
    v_add_f32 v38, v38, v46
    v_add_f32 v39, v39, v47
    v_add_f32 v36, v36, v68
    v_add_f32 v37, v37, v69
    v_add_f32 v38, v38, v70
    v_add_f32 v39, v39, v71
    v_cvt_pk_bf16_f32 v58, v32, v33
    v_cvt_pk_bf16_f32 v59, v34, v35
    v_cvt_pk_bf16_f32 v60, v36, v37
    v_cvt_pk_bf16_f32 v61, v38, v39
    buffer_store_dwordx4 v[58:61], v57, s[16:19], 0 offen
L_sequential_preLN__sliding_local_dilated__glu_gated_geglu__prompt_kernel_done_4:
L_end:
    s_endpgm
.section .rodata,"a"
.p2align 6
.amdhsa_kernel sequential_preLN__sliding_local_dilated__glu_gated_geglu__prompt_kernel
  .amdhsa_next_free_vgpr 168
  .amdhsa_next_free_sgpr 102
  .amdhsa_accum_offset 168
  .amdhsa_group_segment_fixed_size 0
  .amdhsa_kernarg_size 80
  .amdhsa_user_sgpr_count 2
  .amdhsa_user_sgpr_kernarg_segment_ptr 1
  .amdhsa_system_sgpr_workgroup_id_x 1
.end_amdhsa_kernel
```
